```python
import torch

def _softmax(x, axis=-1):
    return torch.softmax(x, dim=axis)
def _gelu(x):
    return torch.nn.functional.gelu(x, approximate="tanh")
def _silu(x):
    return torch.nn.functional.silu(x)
def _sigmoid(x):
    return torch.sigmoid(x)
def _layernorm(x, axis=-1, eps=1e-5):
    m = x.mean(dim=axis, keepdim=True)
    v = x.var(dim=axis, keepdim=True, unbiased=False)
    return (x - m) / torch.sqrt(v + eps)
def _scatter_add(tgt, idx, src, axis=0):
    return tgt.clone().index_add_(axis, idx, src)
def _segment_sum(src, seg, n):
    out = torch.zeros((n,) + src.shape[1:], dtype=src.dtype)
    return out.index_add_(0, seg, src)
def _pad(x, pw):
    flat = tuple(v for pair in reversed(pw) for v in pair)
    return torch.nn.functional.pad(x, flat)

kernel_name = 'concat_heads__spectral_fnet__sliding_block__prompt'

def setup_inputs():

    _w = (lambda a: (lambda t: t.to(torch.bfloat16) if t.is_floating_point() else t)(torch.as_tensor(a)))
    def _A_setup():
        B, S, D = 1, 2048, 448
        ns = torch.arange(S)[:, None] * torch.arange(S)[None, :]
        nd = torch.arange(D)[:, None] * torch.arange(D)[None, :]
        Ws_re = torch.cos(-2.0 * torch.pi * ns / S).to(float)
        Ws_im = torch.sin(-2.0 * torch.pi * ns / S).to(float)
        Wd_re = torch.cos(-2.0 * torch.pi * nd / D).to(float)
        Wd_im = torch.sin(-2.0 * torch.pi * nd / D).to(float)
        return {
            "x": _w((lambda *s: torch.randn(*s, dtype=torch.bfloat16) * 0.05)(B, S, D)),
            "dft_seq_re": _w(Ws_re),
            "dft_seq_im": _w(Ws_im),
            "dft_hid_re": _w(Wd_re),
            "dft_hid_im": _w(Wd_im),
        }
    _A_in = _A_setup()

    def _B_setup():
        B, S, D = 1, 2048, 448
        return {
            "x": _w((lambda *s: torch.randn(*s, dtype=torch.bfloat16) * 0.2)(B, S, D)),
            "wqkv": _w((lambda *s: torch.randn(*s, dtype=torch.bfloat16) * 0.8)(D, 3 * D)),
            "wo": _w((lambda *s: torch.randn(*s, dtype=torch.bfloat16) * 0.2)(D, D)),
        }
    _B_in = _B_setup()

    return {
        "A_x": _A_in["x"],
        "A_dft_seq_re": _A_in["dft_seq_re"],
        "A_dft_seq_im": _A_in["dft_seq_im"],
        "A_dft_hid_re": _A_in["dft_hid_re"],
        "A_dft_hid_im": _A_in["dft_hid_im"],
        "B_x": _B_in["x"],
        "B_wqkv": _B_in["wqkv"],
        "B_wo": _B_in["wo"],
    }

def reference(A_x, A_dft_seq_re, A_dft_seq_im, A_dft_hid_re, A_dft_hid_im, B_x, B_wqkv, B_wo):
    def _A_ref(x, dft_seq_re, dft_seq_im, dft_hid_re, dft_hid_im):
        a = torch.einsum("bsd,ed->bse", x, dft_hid_re)
        b = torch.einsum("bsd,ed->bse", x, dft_hid_im)
        y = torch.einsum("ts,bse->bte", dft_seq_re, a) - torch.einsum("ts,bse->bte", dft_seq_im, b)
        return y

    def _B_ref(x, wqkv, wo):
        B, S, D = x.shape
        H = 16; Dh = D // H; W = 256
        qkv = (lambda x, *d: x.permute(*d))((x @ wqkv).reshape(B, S, 3, H, Dh), 2, 0, 3, 1, 4)
        q, k, v = qkv[0], qkv[1], qkv[2]
        scores = torch.einsum("bhqd,bhkd->bhqk", q, k) * (Dh ** -0.5)
        idx = torch.arange(S)
        mask = (idx[:, None] - idx[None, :] >= 0) & (idx[:, None] - idx[None, :] < W)
        scores = torch.where(mask[None, None], scores, -1e9)
        p = _softmax(scores, axis=-1)
        o = torch.einsum("bhqk,bhkd->bhqd", p, v)
        return (lambda x, *d: x.permute(*d))(o, 0, 2, 1, 3).reshape(B, S, D) @ wo

    a = _A_ref(A_x, A_dft_seq_re, A_dft_seq_im, A_dft_hid_re, A_dft_hid_im)
    b = _B_ref(B_x, B_wqkv, B_wo)
    return torch.concatenate([a, b], axis=-1)
```

```asm
; @launch grid=(256,1,1) block=(512,1,1) lds=163840
.amdgcn_target "amdgcn-amd-amdhsa--gfx950"
.text
.p2align 12
.fill 832, 4, 0xbf810000
.globl concat_heads__spectral_fnet__sliding_block__prompt_kernel
.p2align 8
.type concat_heads__spectral_fnet__sliding_block__prompt_kernel,@function
concat_heads__spectral_fnet__sliding_block__prompt_kernel:
    s_cmpk_ge_u32 s2, 256
    s_cbranch_scc1 L_end
    s_load_dwordx2 s[20:21], s[0:1], 40
    s_load_dwordx2 s[28:29], s[0:1], 48
    s_load_dwordx8 s[12:19], s[0:1], 56
    s_load_dwordx2 s[32:33], s[0:1], 0
    v_readfirstlane_b32 s59, v0
    v_and_b32 v0, 63, v0
    s_and_b32 s3, s2, 7
    s_lshr_b32 s7, s2, 3
    s_lshr_b32 s59, s59, 6
    s_and_b32 s54, s7, 7
    s_lshr_b32 s74, s7, 3
    s_lshl2_add_u32 s53, s3, s74
    s_and_b32 s74, s74, 1
    s_lshl2_add_u32 s74, s74, s54
    s_and_b32 s52, s59, 3
    s_and_b32 s57, s52, 1
    s_lshr_b32 s58, s52, 1
    s_lshl_b32 s78, s52, 10
    s_cmp_lt_u32 s59, 4
    s_cbranch_scc1 L_g2
    s_getpc_b64 s[76:77]
L_pc:
    s_lshl2_add_u32 s75, s7, s52
    s_lshl_b32 s75, s75, 8
    v_lshl_add_u32 v2, v0, 2, s75
    v_min_u32 v2, L_codeend-L_pc-4, v2
    v_mov_b32 v3, s77
    v_add_co_u32 v2, vcc, s76, v2
    s_nop 1
    v_addc_co_u32 v3, vcc, 0, v3, vcc
    global_load_dword v47, v[2:3], off
    s_lshl2_add_u32 s75, s2, s52
    s_mulk_i32 s75, 1184
    v_mul_u32_u24 v2, 20, v0
    s_mov_b32 s30, 0x126000
    s_mov_b32 s31, 0x20000
    s_waitcnt lgkmcnt(0)
    buffer_load_dword v47, v2, s[28:31], s75 offen
    s_branch L_g1
L_g2:
    v_lshrrev_b32 v16, 3, v0
    v_lshl_add_u32 v16, s52, 3, v16
    v_lshrrev_b32 v17, 1, v16
    v_xor_b32 v17, v17, v0
    v_and_b32 v17, 7, v17
    v_lshlrev_b32 v17, 4, v17
    v_mul_u32_u24 v1, 896, v16
    v_add_u32 v1, v1, v17
    v_add_u32 v2, 28672, v1
    v_lshrrev_b32 v18, 2, v0
    v_and_b32 v18, 4, v18
    v_xor_b32 v18, v18, v0
    v_and_b32 v18, 7, v18
    v_mul_u32_u24 v19, 2688, v16
    s_add_u32 s75, s54, 7
    s_lshl_b32 s75, s75, 7
    v_lshl_add_u32 v3, v18, 4, v19
    v_add_u32 v3, s75, v3
    v_add_u32 v4, 86016, v3
    s_sub_u32 s75, s74, 7
    s_cselect_b32 s8, s74, s75
    s_mul_i32 s76, s53, 57344
    s_lshl_b32 s75, s8, 7
    s_add_u32 s60, s75, s76
    s_mul_i32 s67, s8, 172032
    s_add_u32 s68, s67, 172032
    s_add_u32 s61, s60, 128
    s_cmp_eq_u32 s8, 6
    s_cselect_b32 s68, 0, s68
    s_cselect_b32 s61, s76, s61
    s_cmp_eq_u32 s54, 7
    s_cselect_b32 s30, 0, 0x126000
    s_mov_b32 s31, 0x20000
    s_mov_b32 s22, 0x1c0000
    s_mov_b32 s23, 0x20000
    s_mov_b32 m0, s78
    s_waitcnt lgkmcnt(0)
    buffer_load_dwordx4 v1, s[20:23], s60 offen lds
    s_addk_i32 m0, 4096
    s_nop 0
    buffer_load_dwordx4 v2, s[20:23], s60 offen lds
    s_addk_i32 m0, 4096
    s_nop 0
    buffer_load_dwordx4 v3, s[28:31], s67 offen lds
    s_addk_i32 m0, 4096
    s_nop 0
    buffer_load_dwordx4 v4, s[28:31], s67 offen lds
    s_addk_i32 m0, 4096
    s_nop 0
    buffer_load_dwordx4 v1, s[20:23], s61 offen lds
    s_addk_i32 m0, 4096
    s_nop 0
    buffer_load_dwordx4 v2, s[20:23], s61 offen lds
    s_addk_i32 m0, 4096
    s_nop 0
    buffer_load_dwordx4 v3, s[28:31], s68 offen lds
    s_addk_i32 m0, 4096
    s_nop 0
    buffer_load_dwordx4 v4, s[28:31], s68 offen lds
    s_load_dword s6, s[18:19], 0
    s_lshr_b32 s75, s7, 2
    s_lshl3_add_u32 s55, s3, s75
    s_and_b32 s56, s7, 3
    s_add_u32 s62, s61, 128
    s_add_u32 s69, s68, 172032
    s_cmp_eq_u32 s8, 5
    s_cselect_b32 s62, s76, s62
    s_cselect_b32 s69, 0, s69
    s_add_u32 s63, s62, 128
    s_add_u32 s70, s69, 172032
    s_cmp_eq_u32 s8, 4
    s_cselect_b32 s63, s76, s63
    s_cselect_b32 s70, 0, s70
    s_add_u32 s64, s63, 128
    s_add_u32 s71, s70, 172032
    s_cmp_eq_u32 s8, 3
    s_cselect_b32 s64, s76, s64
    s_cselect_b32 s71, 0, s71
    s_add_u32 s65, s64, 128
    s_add_u32 s72, s71, 172032
    s_cmp_eq_u32 s8, 2
    s_cselect_b32 s65, s76, s65
    s_cselect_b32 s72, 0, s72
    s_add_u32 s66, s65, 128
    s_add_u32 s73, s72, 172032
    s_cmp_eq_u32 s8, 1
    s_cselect_b32 s66, s76, s66
    s_cselect_b32 s73, 0, s73
    s_mov_b64 s[48:49], s[28:29]
    s_mov_b32 s50, 0x126000
    s_mov_b32 s51, 0x20000
    s_mov_b64 s[44:45], s[18:19]
    s_mov_b32 s46, 0xb00000
    s_mov_b32 s47, 0x20000
    s_mov_b64 s[36:37], s[12:13]
    s_mov_b32 s38, 0x62000
    s_mov_b32 s39, 0x20000
    s_mov_b64 s[40:41], s[14:15]
    s_mov_b32 s42, 0x380000
    s_mov_b32 s43, 0x20000
    s_mov_b32 s34, 0x1c0000
    s_mov_b32 s35, 0x20000
    s_mul_i32 s3, s55, 896
    v_mul_u32_u24 v7, 57344, v16
    v_add3_u32 v7, v7, v17, s3
    v_min_u32 v20, 6, v18
    s_mul_i32 s3, s54, 112
    v_lshl_add_u32 v5, v20, 4, v19
    v_add_u32 v5, s3, v5
    v_add_u32 v6, 86016, v5
    s_cmp_eq_u32 s54, 7
    s_cselect_b32 s9, 1, 0
    s_cmp_eq_u32 s57, 0
    s_cselect_b32 s9, s9, 2
    s_lshl2_add_u32 s3, s56, s52
    v_and_b32 v40, 15, v0
    v_lshl_add_u32 v40, s3, 4, v40
    v_cvt_f32_u32 v40, v40
    v_mul_f32 v12, 0x3b124925, v40
    v_cos_f32 v10, v12
    v_lshrrev_b32 v40, 1, v0
    v_and_b32 v40, 24, v40
    v_cvt_f32_u32 v40, v40
    v_mul_f32 v13, v12, v40
    v_add_f32 v10, v10, v10
    v_mov_b32 v11, v10
    v_fmamk_f32 v40, v12, 0x0, v13
    v_fmamk_f32 v41, v12, 0x3f800000, v13
    v_cos_f32 v42, v40
    v_sin_f32 v43, v40
    v_cos_f32 v44, v41
    v_sin_f32 v45, v41
    v_cvt_pk_bf16_f32 v144, v42, v44
    v_pk_fma_f32 v[46:47], v[10:11], v[44:45], v[42:43] neg_lo:[0,0,1] neg_hi:[0,0,1]
    v_cvt_pk_bf16_f32 v172, v43, v45
    v_pk_fma_f32 v[48:49], v[10:11], v[46:47], v[44:45] neg_lo:[0,0,1] neg_hi:[0,0,1]
    v_cvt_pk_bf16_f32 v145, v46, v48
    v_pk_fma_f32 v[50:51], v[10:11], v[48:49], v[46:47] neg_lo:[0,0,1] neg_hi:[0,0,1]
    v_cvt_pk_bf16_f32 v173, v47, v49
    v_pk_fma_f32 v[52:53], v[10:11], v[50:51], v[48:49] neg_lo:[0,0,1] neg_hi:[0,0,1]
    v_cvt_pk_bf16_f32 v146, v50, v52
    v_pk_fma_f32 v[54:55], v[10:11], v[52:53], v[50:51] neg_lo:[0,0,1] neg_hi:[0,0,1]
    v_cvt_pk_bf16_f32 v174, v51, v53
    v_pk_fma_f32 v[56:57], v[10:11], v[54:55], v[52:53] neg_lo:[0,0,1] neg_hi:[0,0,1]
    v_cvt_pk_bf16_f32 v147, v54, v56
    v_cvt_pk_bf16_f32 v175, v55, v57
    v_fmamk_f32 v40, v12, 0x42000000, v13
    v_fmamk_f32 v41, v12, 0x42040000, v13
    v_cos_f32 v42, v40
    v_sin_f32 v43, v40
    v_cos_f32 v44, v41
    v_sin_f32 v45, v41
    v_cvt_pk_bf16_f32 v148, v42, v44
    v_pk_fma_f32 v[46:47], v[10:11], v[44:45], v[42:43] neg_lo:[0,0,1] neg_hi:[0,0,1]
    v_cvt_pk_bf16_f32 v176, v43, v45
    v_pk_fma_f32 v[48:49], v[10:11], v[46:47], v[44:45] neg_lo:[0,0,1] neg_hi:[0,0,1]
    v_cvt_pk_bf16_f32 v149, v46, v48
    v_pk_fma_f32 v[50:51], v[10:11], v[48:49], v[46:47] neg_lo:[0,0,1] neg_hi:[0,0,1]
    v_cvt_pk_bf16_f32 v177, v47, v49
    v_pk_fma_f32 v[52:53], v[10:11], v[50:51], v[48:49] neg_lo:[0,0,1] neg_hi:[0,0,1]
    v_cvt_pk_bf16_f32 v150, v50, v52
    v_pk_fma_f32 v[54:55], v[10:11], v[52:53], v[50:51] neg_lo:[0,0,1] neg_hi:[0,0,1]
    v_cvt_pk_bf16_f32 v178, v51, v53
    v_pk_fma_f32 v[56:57], v[10:11], v[54:55], v[52:53] neg_lo:[0,0,1] neg_hi:[0,0,1]
    v_cvt_pk_bf16_f32 v151, v54, v56
    v_cvt_pk_bf16_f32 v179, v55, v57
    v_fmamk_f32 v40, v12, 0x42800000, v13
    v_fmamk_f32 v41, v12, 0x42820000, v13
    v_cos_f32 v42, v40
    v_sin_f32 v43, v40
    v_cos_f32 v44, v41
    v_sin_f32 v45, v41
    v_cvt_pk_bf16_f32 v152, v42, v44
    v_pk_fma_f32 v[46:47], v[10:11], v[44:45], v[42:43] neg_lo:[0,0,1] neg_hi:[0,0,1]
    v_cvt_pk_bf16_f32 v180, v43, v45
    v_pk_fma_f32 v[48:49], v[10:11], v[46:47], v[44:45] neg_lo:[0,0,1] neg_hi:[0,0,1]
    v_cvt_pk_bf16_f32 v153, v46, v48
    v_pk_fma_f32 v[50:51], v[10:11], v[48:49], v[46:47] neg_lo:[0,0,1] neg_hi:[0,0,1]
    v_cvt_pk_bf16_f32 v181, v47, v49
    v_pk_fma_f32 v[52:53], v[10:11], v[50:51], v[48:49] neg_lo:[0,0,1] neg_hi:[0,0,1]
    v_cvt_pk_bf16_f32 v154, v50, v52
    v_pk_fma_f32 v[54:55], v[10:11], v[52:53], v[50:51] neg_lo:[0,0,1] neg_hi:[0,0,1]
    v_cvt_pk_bf16_f32 v182, v51, v53
    v_pk_fma_f32 v[56:57], v[10:11], v[54:55], v[52:53] neg_lo:[0,0,1] neg_hi:[0,0,1]
    v_cvt_pk_bf16_f32 v155, v54, v56
    v_cvt_pk_bf16_f32 v183, v55, v57
    v_fmamk_f32 v40, v12, 0x42c00000, v13
    v_fmamk_f32 v41, v12, 0x42c20000, v13
    v_cos_f32 v42, v40
    v_sin_f32 v43, v40
    v_cos_f32 v44, v41
    v_sin_f32 v45, v41
    v_cvt_pk_bf16_f32 v156, v42, v44
    v_pk_fma_f32 v[46:47], v[10:11], v[44:45], v[42:43] neg_lo:[0,0,1] neg_hi:[0,0,1]
    v_cvt_pk_bf16_f32 v184, v43, v45
    v_pk_fma_f32 v[48:49], v[10:11], v[46:47], v[44:45] neg_lo:[0,0,1] neg_hi:[0,0,1]
    v_cvt_pk_bf16_f32 v157, v46, v48
    v_pk_fma_f32 v[50:51], v[10:11], v[48:49], v[46:47] neg_lo:[0,0,1] neg_hi:[0,0,1]
    v_cvt_pk_bf16_f32 v185, v47, v49
    v_pk_fma_f32 v[52:53], v[10:11], v[50:51], v[48:49] neg_lo:[0,0,1] neg_hi:[0,0,1]
    v_cvt_pk_bf16_f32 v158, v50, v52
    v_pk_fma_f32 v[54:55], v[10:11], v[52:53], v[50:51] neg_lo:[0,0,1] neg_hi:[0,0,1]
    v_cvt_pk_bf16_f32 v186, v51, v53
    v_pk_fma_f32 v[56:57], v[10:11], v[54:55], v[52:53] neg_lo:[0,0,1] neg_hi:[0,0,1]
    v_cvt_pk_bf16_f32 v159, v54, v56
    v_cvt_pk_bf16_f32 v187, v55, v57
    v_fmamk_f32 v40, v12, 0x43000000, v13
    v_fmamk_f32 v41, v12, 0x43010000, v13
    v_cos_f32 v42, v40
    v_sin_f32 v43, v40
    v_cos_f32 v44, v41
    v_sin_f32 v45, v41
    v_cvt_pk_bf16_f32 v160, v42, v44
    v_pk_fma_f32 v[46:47], v[10:11], v[44:45], v[42:43] neg_lo:[0,0,1] neg_hi:[0,0,1]
    v_cvt_pk_bf16_f32 v188, v43, v45
    v_pk_fma_f32 v[48:49], v[10:11], v[46:47], v[44:45] neg_lo:[0,0,1] neg_hi:[0,0,1]
    v_cvt_pk_bf16_f32 v161, v46, v48
    v_pk_fma_f32 v[50:51], v[10:11], v[48:49], v[46:47] neg_lo:[0,0,1] neg_hi:[0,0,1]
    v_cvt_pk_bf16_f32 v189, v47, v49
    v_pk_fma_f32 v[52:53], v[10:11], v[50:51], v[48:49] neg_lo:[0,0,1] neg_hi:[0,0,1]
    v_cvt_pk_bf16_f32 v162, v50, v52
    v_pk_fma_f32 v[54:55], v[10:11], v[52:53], v[50:51] neg_lo:[0,0,1] neg_hi:[0,0,1]
    v_cvt_pk_bf16_f32 v190, v51, v53
    v_pk_fma_f32 v[56:57], v[10:11], v[54:55], v[52:53] neg_lo:[0,0,1] neg_hi:[0,0,1]
    v_cvt_pk_bf16_f32 v163, v54, v56
    v_cvt_pk_bf16_f32 v191, v55, v57
    v_fmamk_f32 v40, v12, 0x43200000, v13
    v_fmamk_f32 v41, v12, 0x43210000, v13
    v_cos_f32 v42, v40
    v_sin_f32 v43, v40
    v_cos_f32 v44, v41
    v_sin_f32 v45, v41
    v_cvt_pk_bf16_f32 v164, v42, v44
    v_pk_fma_f32 v[46:47], v[10:11], v[44:45], v[42:43] neg_lo:[0,0,1] neg_hi:[0,0,1]
    v_cvt_pk_bf16_f32 v192, v43, v45
    v_pk_fma_f32 v[48:49], v[10:11], v[46:47], v[44:45] neg_lo:[0,0,1] neg_hi:[0,0,1]
    v_cvt_pk_bf16_f32 v165, v46, v48
    v_pk_fma_f32 v[50:51], v[10:11], v[48:49], v[46:47] neg_lo:[0,0,1] neg_hi:[0,0,1]
    v_cvt_pk_bf16_f32 v193, v47, v49
    v_pk_fma_f32 v[52:53], v[10:11], v[50:51], v[48:49] neg_lo:[0,0,1] neg_hi:[0,0,1]
    v_cvt_pk_bf16_f32 v166, v50, v52
    v_pk_fma_f32 v[54:55], v[10:11], v[52:53], v[50:51] neg_lo:[0,0,1] neg_hi:[0,0,1]
    v_cvt_pk_bf16_f32 v194, v51, v53
    v_pk_fma_f32 v[56:57], v[10:11], v[54:55], v[52:53] neg_lo:[0,0,1] neg_hi:[0,0,1]
    v_cvt_pk_bf16_f32 v167, v54, v56
    v_cvt_pk_bf16_f32 v195, v55, v57
    v_fmamk_f32 v40, v12, 0x43400000, v13
    v_fmamk_f32 v41, v12, 0x43410000, v13
    v_cos_f32 v42, v40
    v_sin_f32 v43, v40
    v_cos_f32 v44, v41
    v_sin_f32 v45, v41
    v_cvt_pk_bf16_f32 v168, v42, v44
    v_pk_fma_f32 v[46:47], v[10:11], v[44:45], v[42:43] neg_lo:[0,0,1] neg_hi:[0,0,1]
    v_cvt_pk_bf16_f32 v196, v43, v45
    v_pk_fma_f32 v[48:49], v[10:11], v[46:47], v[44:45] neg_lo:[0,0,1] neg_hi:[0,0,1]
    v_cvt_pk_bf16_f32 v169, v46, v48
    v_pk_fma_f32 v[50:51], v[10:11], v[48:49], v[46:47] neg_lo:[0,0,1] neg_hi:[0,0,1]
    v_cvt_pk_bf16_f32 v197, v47, v49
    v_pk_fma_f32 v[52:53], v[10:11], v[50:51], v[48:49] neg_lo:[0,0,1] neg_hi:[0,0,1]
    v_cvt_pk_bf16_f32 v170, v50, v52
    v_pk_fma_f32 v[54:55], v[10:11], v[52:53], v[50:51] neg_lo:[0,0,1] neg_hi:[0,0,1]
    v_cvt_pk_bf16_f32 v198, v51, v53
    v_pk_fma_f32 v[56:57], v[10:11], v[54:55], v[52:53] neg_lo:[0,0,1] neg_hi:[0,0,1]
    v_cvt_pk_bf16_f32 v171, v54, v56
    v_cvt_pk_bf16_f32 v199, v55, v57
    v_and_b32 v40, 15, v0
    v_cvt_f32_u32 v40, v40
    v_mul_f32 v12, 0x3d000000, v40
    v_lshrrev_b32 v40, 2, v0
    v_and_b32 v40, 12, v40
    v_cvt_f32_u32 v40, v40
    v_mul_f32 v42, v12, v40
    v_add_f32 v43, v12, v42
    v_add_f32 v44, v12, v43
    v_add_f32 v45, v12, v44
    v_sin_f32 v46, v42
    v_sin_f32 v47, v43
    v_sin_f32 v48, v44
    v_sin_f32 v49, v45
    v_cos_f32 v42, v42
    v_cos_f32 v43, v43
    v_cos_f32 v44, v44
    v_cos_f32 v45, v45
    v_and_b32 v40, 1, v0
    s_mov_b32 s3, 0x80008000
    v_mul_lo_u32 v40, v40, s3
    s_brev_b32 s3, 1
    v_cvt_pk_bf16_f32 v96, v42, v43
    v_cvt_pk_bf16_f32 v97, v44, v45
    v_cvt_pk_bf16_f32 v104, v46, v47
    v_cvt_pk_bf16_f32 v105, v48, v49
    v_xor_b32 v98, v40, v96
    v_xor_b32 v99, v40, v97
    v_xor_b32 v106, v40, v104
    v_xor_b32 v107, v40, v105
    v_xor_b32 v100, s3, v96
    v_xor_b32 v101, s3, v97
    v_xor_b32 v102, s3, v98
    v_xor_b32 v103, s3, v99
    v_xor_b32 v108, s3, v104
    v_xor_b32 v109, s3, v105
    v_xor_b32 v110, s3, v106
    v_xor_b32 v111, s3, v107
    v_and_b32 v40, 15, v0
    v_lshrrev_b32 v41, 1, v40
    v_lshlrev_b32 v40, 7, v40
    v_add_u32 v40, 114688, v40
    v_lshrrev_b32 v42, 4, v0
    v_xor_b32 v42, v42, v41
    v_lshl_add_u32 v8, v42, 4, v40
    v_xor_b32 v9, 64, v8
    v_lshl_or_b32 v11, v0, 31, 1.0
    v_mov_b32 v15, 147392
    s_waitcnt lgkmcnt(0)
    s_mul_i32 s6, s6, 0x9E3779C1
    s_add_u32 s6, s6, 0x7FEB3560
    s_cmp_eq_u32 s52, 0
    s_cbranch_scc0 sk_1
    s_getreg_b32 s16, hwreg(HW_REG_XCC_ID, 0, 4)
    s_lshl_b32 s79, s53, 7
    s_add_u32 s76, s79, 0x30000
    s_lshl2_add_u32 s79, s54, s76
    s_add_u32 s16, s16, s6
    s_mov_b32 s17, s16
    s_atomic_swap s17, s[18:19], s79
sk_1:
    s_lshl3_add_u32 s3, s53, s54
    s_lshl_b32 s3, s3, 7
    s_lshl_b32 s7, s52, 15
    s_add_u32 s3, s3, s7
    s_add_u32 s3, s3, 0x10000
    s_load_dword s1, s[18:19], s3 glc
    s_cmp_eq_u32 s54, 7
    s_cbranch_scc1 L_p7
    s_add_u32 m0, s78, 32768
    s_nop 0
    buffer_load_dwordx4 v1, s[20:23], s62 offen lds
    s_add_u32 m0, s78, 40960
    s_nop 0
    buffer_load_dwordx4 v3, s[28:31], s69 offen lds
    s_add_u32 m0, s78, 36864
    s_nop 0
    buffer_load_dwordx4 v2, s[20:23], s62 offen lds
    s_add_u32 m0, s78, 45056
    s_nop 0
    buffer_load_dwordx4 v4, s[28:31], s69 offen lds
    s_waitcnt vmcnt(8)
    s_barrier
    s_add_u32 m0, s78, 49152
    s_nop 0
    buffer_load_dwordx4 v1, s[20:23], s63 offen lds
    s_add_u32 m0, s78, 57344
    s_nop 0
    buffer_load_dwordx4 v3, s[28:31], s70 offen lds
    s_add_u32 m0, s78, 53248
    s_nop 0
    buffer_load_dwordx4 v2, s[20:23], s63 offen lds
    s_add_u32 m0, s78, 61440
    s_nop 0
    buffer_load_dwordx4 v4, s[28:31], s70 offen lds
    v_lshlrev_b32 v14, 4, v0
    s_mul_i32 s0, s52, 1792
    v_add_u32 v127, s0, v14
    s_nop 0
    s_nop 0
    s_lshl3_add_u32 s3, s53, s54
    s_lshl_b32 s3, s3, 7
    s_mul_i32 s7, s58, 0x8000
    s_add_u32 s3, s3, s7
    s_add_u32 s77, s3, 0x10000
    s_mul_i32 s75, s54, 229376
    s_mul_i32 s3, s53, 7168
    s_add_u32 s3, s3, s75
    s_add_u32 s8, s3, 0x201000
    s_sub_u32 s3, s8, 28672
    s_cmp_lt_u32 s53, 4
    s_cselect_b32 s12, s46, s3
    s_sub_u32 s3, s8, 21504
    s_waitcnt vmcnt(8)
    s_barrier
    s_add_u32 m0, s78, 65536
    s_nop 0
    buffer_load_dwordx4 v1, s[20:23], s64 offen lds
    s_add_u32 m0, s78, 73728
    s_nop 0
    buffer_load_dwordx4 v3, s[28:31], s71 offen lds
    s_add_u32 m0, s78, 69632
    s_nop 0
    buffer_load_dwordx4 v2, s[20:23], s64 offen lds
    s_add_u32 m0, s78, 77824
    s_nop 0
    buffer_load_dwordx4 v4, s[28:31], s71 offen lds
    s_cmp_eq_u32 s52, 0
    s_cbranch_scc1 L_pad_roleT
    s_branch L_pad_g1p1
L_hopret:
    s_waitcnt vmcnt(8)
    s_barrier
    s_add_u32 m0, s78, 81920
    s_nop 0
    buffer_load_dwordx4 v1, s[20:23], s65 offen lds
    s_add_u32 m0, s78, 90112
    s_nop 0
    buffer_load_dwordx4 v3, s[28:31], s72 offen lds
    s_add_u32 m0, s78, 86016
    s_nop 0
    buffer_load_dwordx4 v2, s[20:23], s65 offen lds
    s_add_u32 m0, s78, 94208
    s_nop 0
    buffer_load_dwordx4 v4, s[28:31], s72 offen lds
    s_cmp_lt_u32 s53, 3
    s_cselect_b32 s13, s46, s3
    s_sub_u32 s3, s8, 14336
    s_cmp_lt_u32 s53, 2
    s_cselect_b32 s14, s46, s3
    s_sub_u32 s3, s8, 7168
    s_cmp_lt_u32 s53, 1
    s_cselect_b32 s15, s46, s3
    s_mul_i32 s3, s52, 10
    v_lshrrev_b32 v132, 1, v0
    v_add_u32 v132, s3, v132
    v_lshl_add_u32 v133, s53, 3, v132
    v_cmp_le_u32 vcc, 32, v133
    v_mov_b32 v129, 0x3f803f80
    v_and_b32 v133, 1, v0
    v_cndmask_b32 v128, 0, v129, vcc
    v_lshlrev_b32 v133, 6, v133
    v_lshl_add_u32 v132, v132, 10, v133
    s_waitcnt vmcnt(8)
    s_barrier
    s_add_u32 m0, s78, 98304
    s_nop 0
    buffer_load_dwordx4 v1, s[20:23], s66 offen lds
    s_add_u32 m0, s78, 106496
    s_nop 0
    buffer_load_dwordx4 v3, s[28:31], s73 offen lds
    s_add_u32 m0, s78, 102400
    s_nop 0
    buffer_load_dwordx4 v2, s[20:23], s66 offen lds
    s_add_u32 m0, s78, 110592
    s_nop 0
    buffer_load_dwordx4 v4, s[28:31], s73 offen lds
    v_mov_b32 v129, v128
    v_mov_b32 v130, v128
    v_mov_b32 v131, v128
    v_add_u32 v134, 98304, v14
    s_add_u32 s3, s54, s58
    s_and_b32 s3, s3, 7
    s_lshl_b32 s3, s3, 5
    s_sub_u32 s3, s3, s58
    s_lshl2_add_u32 s3, s3, 0x10004
    s_add_u32 s7, s53, 0
    s_and_b32 s7, s7, 31
    s_lshl_b32 s7, s7, 10
    s_add_u32 s24, s7, s3
    s_add_u32 s3, s3, 8
    s_add_u32 s7, s53, 1
    s_and_b32 s7, s7, 31
    s_lshl_b32 s7, s7, 10
    s_add_u32 s25, s7, s3
    s_waitcnt vmcnt(8)
    s_barrier
    s_add_u32 m0, s78, 114688
    s_nop 0
    buffer_load_dwordx4 v7, s[32:35], 0 offen offset:0 lds
    s_add_u32 m0, s78, 118656
    s_nop 0
    buffer_load_dwordx4 v7, s[32:35], 0 offen offset:128 lds
    s_add_u32 m0, s78, 122624
    s_nop 0
    buffer_load_dwordx4 v7, s[32:35], 0 offen offset:256 lds
    s_add_u32 m0, s78, 126592
    s_nop 0
    buffer_load_dwordx4 v7, s[32:35], 0 offen offset:384 lds
    s_add_u32 s3, s3, 8
    s_add_u32 s7, s53, 2
    s_and_b32 s7, s7, 31
    s_lshl_b32 s7, s7, 10
    s_add_u32 s26, s7, s3
    s_add_u32 s3, s3, 8
    s_add_u32 s7, s53, 3
    s_and_b32 s7, s7, 31
    s_lshl_b32 s7, s7, 10
    s_add_u32 s27, s7, s3
    s_add_u32 s3, s3, 8
    s_add_u32 s7, s53, 4
    s_and_b32 s7, s7, 31
    s_lshl_b32 s7, s7, 10
    s_add_u32 s11, s7, s3
    s_add_u32 s3, s3, 8
    s_add_u32 s4, s18, 0x8000
    s_addc_u32 s5, s19, 0
    s_waitcnt vmcnt(8)
    s_barrier
    s_add_u32 m0, s78, 130560
    s_nop 0
    buffer_load_dwordx4 v7, s[32:35], 0 offen offset:512 lds
    s_add_u32 m0, s78, 134528
    s_nop 0
    buffer_load_dwordx4 v7, s[32:35], 0 offen offset:640 lds
    s_add_u32 m0, s78, 138496
    s_nop 0
    buffer_load_dwordx4 v7, s[32:35], 0 offen offset:768 lds
    s_waitcnt vmcnt(7)
    s_barrier
    s_add_u32 m0, s78, 147456
    s_nop 0
    buffer_load_dwordx4 v5, s[48:51], s67 offen lds
    s_addk_i32 m0, 4096
    s_nop 0
    buffer_load_dwordx4 v6, s[48:51], s67 offen lds
    s_add_u32 m0, s78, 155648
    s_nop 0
    buffer_load_dwordx4 v5, s[48:51], s68 offen lds
    s_addk_i32 m0, 4096
    s_nop 0
    buffer_load_dwordx4 v6, s[48:51], s68 offen lds
    s_lshl1_add_u32 s3, s78, 98304
    v_lshl_add_u32 v121, v0, 4, s3
    v_and_b32 v18, 15, v0
    v_lshl_add_u32 v19, v18, 6, s3
    v_lshrrev_b32 v18, 3, v0
    v_xor_b32 v20, v18, v0
    v_bfe_u32 v21, v20, 1, 2
    v_lshl_add_u32 v140, v21, 4, v19
    v_and_b32 v20, 3, v20
    v_lshlrev_b32 v142, 4, v20
    v_lshrrev_b32 v143, 2, v0
    v_mul_u32_u24 v18, 65920, v143
    v_add_u32 v141, v18, v142
    s_lshl1_add_u32 s3, s56, s58
    s_lshl_b32 s3, s3, 13
    s_lshl1_add_u32 s7, s55, s57
    s_lshl_b32 s7, s7, 6
    s_add_u32 s3, s3, s7
    s_add_u32 s74, s3, 0x7f0000
    s_branch L_ja_g2p1
    .p2alignl 12, 0xbf810000
L_ja_g2p1:
    s_waitcnt vmcnt(4)
    s_barrier
    ds_read_b128 v[24:27], v8 offset:0
    ds_read_b128 v[28:31], v8 offset:2048
    ds_read_b128 v[32:35], v9 offset:0
    ds_read_b128 v[36:39], v9 offset:2048
    ds_read_b128 v[40:43], v8 offset:4096
    ds_read_b128 v[44:47], v8 offset:6144
    ds_read_b128 v[48:51], v9 offset:4096
    ds_read_b128 v[52:55], v9 offset:6144
    ds_read_b128 v[56:59], v8 offset:8192
    ds_read_b128 v[60:63], v8 offset:10240
    s_add_u32 m0, s78, 0
    s_nop 0
    buffer_load_dwordx4 v5, s[48:51], s69 offen lds
    s_addk_i32 m0, 4096
    s_nop 0
    buffer_load_dwordx4 v6, s[48:51], s69 offen lds
    s_waitcnt lgkmcnt(8)
    v_mfma_f32_16x16x32_bf16 v[64:67], v[24:27], v[144:147], 0
    v_mfma_f32_16x16x32_bf16 v[72:75], v[24:27], v[172:175], 0
    ds_read_b128 v[112:115], v9 offset:8192
    ds_read_b128 v[116:119], v9 offset:10240
    v_mfma_f32_16x16x32_bf16 v[68:71], v[28:31], v[144:147], 0
    v_mfma_f32_16x16x32_bf16 v[76:79], v[28:31], v[172:175], 0
    s_waitcnt lgkmcnt(8)
    v_mfma_f32_16x16x32_bf16 v[64:67], v[32:35], v[148:151], v[64:67]
    v_mfma_f32_16x16x32_bf16 v[72:75], v[32:35], v[176:179], v[72:75]
    ds_read_b128 v[24:27], v8 offset:12288
    ds_read_b128 v[28:31], v8 offset:14336
    v_mfma_f32_16x16x32_bf16 v[68:71], v[36:39], v[148:151], v[68:71]
    v_mfma_f32_16x16x32_bf16 v[76:79], v[36:39], v[176:179], v[76:79]
    s_waitcnt lgkmcnt(8)
    v_mfma_f32_16x16x32_bf16 v[64:67], v[40:43], v[152:155], v[64:67]
    v_mfma_f32_16x16x32_bf16 v[72:75], v[40:43], v[180:183], v[72:75]
    ds_read_b128 v[32:35], v9 offset:12288
    ds_read_b128 v[36:39], v9 offset:14336
    v_mfma_f32_16x16x32_bf16 v[68:71], v[44:47], v[152:155], v[68:71]
    v_mfma_f32_16x16x32_bf16 v[76:79], v[44:47], v[180:183], v[76:79]
    s_waitcnt lgkmcnt(8)
    v_mfma_f32_16x16x32_bf16 v[64:67], v[48:51], v[156:159], v[64:67]
    v_mfma_f32_16x16x32_bf16 v[72:75], v[48:51], v[184:187], v[72:75]
    ds_read_b128 v[40:43], v8 offset:16384
    ds_read_b128 v[44:47], v8 offset:18432
    v_mfma_f32_16x16x32_bf16 v[68:71], v[52:55], v[156:159], v[68:71]
    v_mfma_f32_16x16x32_bf16 v[76:79], v[52:55], v[184:187], v[76:79]
    s_waitcnt lgkmcnt(8)
    v_mfma_f32_16x16x32_bf16 v[64:67], v[56:59], v[160:163], v[64:67]
    v_mfma_f32_16x16x32_bf16 v[72:75], v[56:59], v[188:191], v[72:75]
    ds_read_b128 v[48:51], v9 offset:16384
    ds_read_b128 v[52:55], v9 offset:18432
    v_mfma_f32_16x16x32_bf16 v[68:71], v[60:63], v[160:163], v[68:71]
    v_mfma_f32_16x16x32_bf16 v[76:79], v[60:63], v[188:191], v[76:79]
    s_waitcnt lgkmcnt(8)
    v_mfma_f32_16x16x32_bf16 v[64:67], v[112:115], v[164:167], v[64:67]
    v_mfma_f32_16x16x32_bf16 v[72:75], v[112:115], v[192:195], v[72:75]
    ds_read_b128 v[56:59], v8 offset:20480
    ds_read_b128 v[60:63], v8 offset:22528
    v_mfma_f32_16x16x32_bf16 v[68:71], v[116:119], v[164:167], v[68:71]
    v_mfma_f32_16x16x32_bf16 v[76:79], v[116:119], v[192:195], v[76:79]
    s_waitcnt lgkmcnt(8)
    v_mfma_f32_16x16x32_bf16 v[64:67], v[24:27], v[168:171], v[64:67]
    v_mfma_f32_16x16x32_bf16 v[72:75], v[24:27], v[196:199], v[72:75]
    ds_read_b128 v[112:115], v9 offset:20480
    ds_read_b128 v[116:119], v9 offset:22528
    v_mfma_f32_16x16x32_bf16 v[68:71], v[28:31], v[168:171], v[68:71]
    v_mfma_f32_16x16x32_bf16 v[76:79], v[28:31], v[196:199], v[76:79]
    s_waitcnt lgkmcnt(8)
    v_mfma_f32_16x16x32_bf16 v[200:203], v[32:35], v[144:147], 0
    v_mfma_f32_16x16x32_bf16 v[208:211], v[32:35], v[172:175], 0
    ds_read_b128 v[24:27], v8 offset:24576
    ds_read_b128 v[28:31], v8 offset:26624
    v_mfma_f32_16x16x32_bf16 v[204:207], v[36:39], v[144:147], 0
    v_mfma_f32_16x16x32_bf16 v[212:215], v[36:39], v[172:175], 0
    s_waitcnt lgkmcnt(8)
    v_mfma_f32_16x16x32_bf16 v[200:203], v[40:43], v[148:151], v[200:203]
    v_mfma_f32_16x16x32_bf16 v[208:211], v[40:43], v[176:179], v[208:211]
    ds_read_b128 v[32:35], v9 offset:24576
    ds_read_b128 v[36:39], v9 offset:26624
    v_mfma_f32_16x16x32_bf16 v[204:207], v[44:47], v[148:151], v[204:207]
    v_mfma_f32_16x16x32_bf16 v[212:215], v[44:47], v[176:179], v[212:215]
    s_waitcnt lgkmcnt(8)
    v_mfma_f32_16x16x32_bf16 v[200:203], v[48:51], v[152:155], v[200:203]
    v_mfma_f32_16x16x32_bf16 v[208:211], v[48:51], v[180:183], v[208:211]
    v_mfma_f32_16x16x32_bf16 v[204:207], v[52:55], v[152:155], v[204:207]
    v_mfma_f32_16x16x32_bf16 v[212:215], v[52:55], v[180:183], v[212:215]
    s_add_u32 m0, s78, 8192
    s_nop 0
    buffer_load_dwordx4 v5, s[48:51], s70 offen lds
    s_addk_i32 m0, 4096
    s_nop 0
    buffer_load_dwordx4 v6, s[48:51], s70 offen lds
    s_waitcnt lgkmcnt(6)
    v_mfma_f32_16x16x32_bf16 v[200:203], v[56:59], v[156:159], v[200:203]
    v_mfma_f32_16x16x32_bf16 v[208:211], v[56:59], v[184:187], v[208:211]
    v_mfma_f32_16x16x32_bf16 v[204:207], v[60:63], v[156:159], v[204:207]
    v_mfma_f32_16x16x32_bf16 v[212:215], v[60:63], v[184:187], v[212:215]
    s_waitcnt lgkmcnt(4)
    v_mfma_f32_16x16x32_bf16 v[200:203], v[112:115], v[160:163], v[200:203]
    v_mfma_f32_16x16x32_bf16 v[208:211], v[112:115], v[188:191], v[208:211]
    v_mfma_f32_16x16x32_bf16 v[204:207], v[116:119], v[160:163], v[204:207]
    v_mfma_f32_16x16x32_bf16 v[212:215], v[116:119], v[188:191], v[212:215]
    s_waitcnt lgkmcnt(2)
    v_mfma_f32_16x16x32_bf16 v[200:203], v[24:27], v[164:167], v[200:203]
    v_mfma_f32_16x16x32_bf16 v[208:211], v[24:27], v[192:195], v[208:211]
    v_mfma_f32_16x16x32_bf16 v[204:207], v[28:31], v[164:167], v[204:207]
    v_mfma_f32_16x16x32_bf16 v[212:215], v[28:31], v[192:195], v[212:215]
    s_add_u32 m0, s78, 16384
    s_nop 0
    buffer_load_dwordx4 v5, s[48:51], s71 offen lds
    s_addk_i32 m0, 4096
    s_nop 0
    buffer_load_dwordx4 v6, s[48:51], s71 offen lds
    s_waitcnt lgkmcnt(0)
    v_mfma_f32_16x16x32_bf16 v[200:203], v[32:35], v[168:171], v[200:203]
    v_mfma_f32_16x16x32_bf16 v[208:211], v[32:35], v[196:199], v[208:211]
    v_mfma_f32_16x16x32_bf16 v[204:207], v[36:39], v[168:171], v[204:207]
    v_mfma_f32_16x16x32_bf16 v[212:215], v[36:39], v[196:199], v[212:215]
L_p7join:
    s_nop 4
    v_fmac_f32 v64, v11, v200
    v_fmac_f32 v65, v11, v201
    v_fmac_f32 v66, v11, v202
    v_fmac_f32 v67, v11, v203
    v_fmac_f32 v68, v11, v204
    v_fmac_f32 v69, v11, v205
    v_fmac_f32 v70, v11, v206
    v_fmac_f32 v71, v11, v207
    v_fmac_f32 v72, v11, v208
    v_fmac_f32 v73, v11, v209
    v_fmac_f32 v74, v11, v210
    v_fmac_f32 v75, v11, v211
    v_fmac_f32 v76, v11, v212
    v_fmac_f32 v77, v11, v213
    v_fmac_f32 v78, v11, v214
    v_fmac_f32 v79, v11, v215
    v_cvt_pk_bf16_f32 v80, v64, v65
    v_cvt_pk_bf16_f32 v81, v66, v67
    v_cvt_pk_bf16_f32 v82, v68, v69
    v_cvt_pk_bf16_f32 v83, v70, v71
    v_cvt_pk_bf16_f32 v84, v72, v73
    v_cvt_pk_bf16_f32 v85, v74, v75
    v_cvt_pk_bf16_f32 v86, v76, v77
    v_cvt_pk_bf16_f32 v87, v78, v79
    v_cvt_pk_bf16_f32 v88, -v72, -v73
    v_cvt_pk_bf16_f32 v89, -v74, -v75
    v_cvt_pk_bf16_f32 v90, -v76, -v77
    v_cvt_pk_bf16_f32 v91, -v78, -v79
    s_add_u32 m0, s78, 24576
    s_nop 0
    buffer_load_dwordx4 v5, s[48:51], s72 offen lds
    s_addk_i32 m0, 4096
    s_nop 0
    buffer_load_dwordx4 v6, s[48:51], s72 offen lds
    v_mfma_f32_16x16x32_bf16 v[40:43], v[80:83], v[96:99], 0
    v_mfma_f32_16x16x32_bf16 v[44:47], v[80:83], v[104:107], 0
    v_mfma_f32_16x16x32_bf16 v[48:51], v[80:83], v[100:103], 0
    v_mfma_f32_16x16x32_bf16 v[52:55], v[80:83], v[108:111], 0
    v_mfma_f32_16x16x32_bf16 v[40:43], v[88:91], v[104:107], v[40:43]
    v_mfma_f32_16x16x32_bf16 v[44:47], v[84:87], v[96:99], v[44:47]
    v_mfma_f32_16x16x32_bf16 v[48:51], v[88:91], v[108:111], v[48:51]
    v_mfma_f32_16x16x32_bf16 v[52:55], v[84:87], v[100:103], v[52:55]
    s_nop 5
    v_cvt_pk_bf16_f32 v56, v40, v44
    v_cvt_pk_bf16_f32 v57, v41, v45
    v_cvt_pk_bf16_f32 v58, v42, v46
    v_cvt_pk_bf16_f32 v59, v43, v47
    v_cvt_pk_bf16_f32 v60, v48, v52
    v_cvt_pk_bf16_f32 v61, v49, v53
    v_cvt_pk_bf16_f32 v62, v50, v54
    v_cvt_pk_bf16_f32 v63, v51, v55
    ds_write_b128 v140, v[56:59] offset:8192
    ds_write_b128 v140, v[60:63] offset:9216
    ds_read_b128 v[24:27], v121 offset:8192
    ds_read_b128 v[28:31], v121 offset:9216
    s_add_u32 m0, s78, 32768
    s_nop 0
    buffer_load_dwordx4 v5, s[48:51], s73 offen lds
    s_addk_i32 m0, 4096
    s_nop 0
    buffer_load_dwordx4 v6, s[48:51], s73 offen lds
    s_waitcnt vmcnt(8)
    s_barrier
    s_cmp_eq_u32 s54, 7
    s_cbranch_scc1 L_p7b
    s_cmp_eq_u32 s9, 0
    s_cbranch_scc0 sk_2
    s_atomic_swap s6, s[18:19], s24
    s_atomic_swap s6, s[18:19], s25
    s_atomic_swap s6, s[18:19], s26
    s_atomic_swap s6, s[18:19], s27
    s_atomic_swap s6, s[18:19], s11
sk_2:
    v_add_u32 v3, 896, v3
    v_add_u32 v4, 896, v4
    s_mov_b64 s[60:61], s[28:29]
    s_mov_b32 s62, s30
    s_mov_b32 s63, 0x20000
    s_add_u32 m0, s78, 40960
    s_nop 0
    buffer_load_dwordx4 v3, s[60:63], s67 offen lds
    s_addk_i32 m0, 4096
    s_nop 0
    buffer_load_dwordx4 v4, s[60:63], s67 offen lds
    s_add_u32 m0, s78, 49152
    s_nop 0
    buffer_load_dwordx4 v3, s[60:63], s68 offen lds
    s_addk_i32 m0, 4096
    s_nop 0
    buffer_load_dwordx4 v4, s[60:63], s68 offen lds
    v_lshrrev_b32 v18, 3, v0
    v_lshl_add_u32 v18, s52, 3, v18
    v_mul_u32_u24 v12, 896, v18
    v_and_b32 v18, 4, v143
    v_xor_b32 v18, v18, v0
    v_and_b32 v18, 7, v18
    s_lshl_b32 s3, s54, 7
    v_lshl_add_u32 v12, v18, 4, v12
    v_add_u32 v12, s3, v12
    v_add_u32 v13, 28672, v12
    s_and_b32 s65, s53, 3
    s_mul_i32 s65, s65, 0
    s_cmp_eq_u32 s54, 7
    s_cselect_b32 s38, 0, s38
    s_add_u32 s66, s78, 40960
    v_and_b32 v16, 31, v0
    v_lshrrev_b32 v17, 5, v0
    v_bfe_u32 v18, v0, 1, 2
    v_xor_b32 v18, v18, v17
    s_lshl1_add_u32 s3, s78, 98304
    v_lshl_add_u32 v19, v16, 6, s3
    v_lshl_add_u32 v122, v18, 4, v19
    v_xor_b32 v123, 32, v122
    v_mul_u32_u24 v124, 1792, v143
    v_add_u32 v124, v124, v142
    v_add_u32 v125, 28672, v124
    s_lshl_b32 s3, s57, 12
    v_lshl_add_u32 v126, v16, 3, s3
    v_lshl_add_u32 v126, v17, 9, v126
    s_lshl1_add_u32 s3, s53, s57
    s_waitcnt vmcnt(8)
    s_barrier
    s_add_u32 m0, s78, 57344
    s_nop 0
    buffer_load_dwordx4 v3, s[60:63], s69 offen lds
    s_addk_i32 m0, 4096
    s_nop 0
    buffer_load_dwordx4 v4, s[60:63], s69 offen lds
    s_add_u32 m0, s78, 65536
    s_nop 0
    buffer_load_dwordx4 v3, s[60:63], s70 offen lds
    s_addk_i32 m0, 4096
    s_nop 0
    buffer_load_dwordx4 v4, s[60:63], s70 offen lds
    s_mul_i32 s3, s3, 57344
    s_lshl1_add_u32 s7, s54, s58
    s_lshl_b32 s7, s7, 6
    s_add_u32 s3, s3, s7
    s_add_u32 s10, s3, 896
    s_lshl_b32 s3, s58, 6
    s_add_u32 s3, s3, 40960
    v_bfe_u32 v18, v0, 4, 1
    v_lshl_add_u32 v18, v18, 5, s3
    v_and_b32 v19, 1, v0
    v_lshl_add_u32 v18, v19, 4, v18
    v_bfe_u32 v19, v0, 1, 1
    v_lshl_add_u32 v18, v19, 3, v18
    v_and_b32 v19, 8, v0
    v_lshlrev_b32 v19, 3, v19
    v_xor_b32 v18, v18, v19
    s_waitcnt vmcnt(10)
    s_barrier
    s_add_u32 m0, s78, 73728
    s_nop 0
    buffer_load_dwordx4 v3, s[60:63], s71 offen lds
    s_addk_i32 m0, 4096
    s_nop 0
    buffer_load_dwordx4 v4, s[60:63], s71 offen lds
    v_and_b32 v19, 44, v0
    v_lshl_add_u32 v120, v19, 5, v18
    s_cmp_eq_u32 s58, 1
    s_cselect_b64 vcc, -1, 0
    s_lshl_b32 s3, s57, 10
    s_add_u32 s3, s3, s53
    v_lshl_add_u32 v18, v143, 5, s3
    v_sub_u32 v19, 0, v18
    s_waitcnt vmcnt(10)
    s_barrier
    s_add_u32 m0, s78, 81920
    s_nop 0
    buffer_load_dwordx4 v3, s[60:63], s72 offen lds
    s_addk_i32 m0, 4096
    s_nop 0
    buffer_load_dwordx4 v4, s[60:63], s72 offen lds
    v_and_b32 v19, 2047, v19
    v_cndmask_b32 v19, v18, v19, vcc
    v_mul_u32_u24 v19, 1792, v19
    v_add_u32 v136, v19, v142
    v_add_u32 v18, 512, v18
    v_sub_u32 v19, 0, v18
    v_and_b32 v19, 2047, v19
    v_cndmask_b32 v19, v18, v19, vcc
    s_waitcnt vmcnt(10)
    s_barrier
    s_add_u32 m0, s78, 90112
    s_nop 0
    buffer_load_dwordx4 v3, s[60:63], s73 offen lds
    s_addk_i32 m0, 4096
    s_nop 0
    buffer_load_dwordx4 v4, s[60:63], s73 offen lds
    s_waitcnt lgkmcnt(0)
    buffer_store_dwordx4 v[24:27], v141, s[44:47], s74 offen sc1
    s_add_u32 s74, s74, 1054720
    buffer_store_dwordx4 v[28:31], v141, s[44:47], s74 offen sc1
    s_cmp_eq_u32 s52, 1
    s_cbranch_scc0 sk_3
    s_load_dwordx16 s[20:35], s[18:19], s77 glc
sk_3:
    s_waitcnt vmcnt(12)
    s_barrier
    v_mul_u32_u24 v19, 1792, v19
    v_add_u32 v137, v19, v142
    s_lshl_b32 s3, s54, 6
    s_sub_u32 s7, 832, s3
    s_cmp_eq_u32 s58, 1
    s_cselect_b32 s64, s7, s3
    v_and_b32 v18, 19, v0
    v_bfe_u32 v19, v0, 2, 1
    v_lshl_add_u32 v18, v19, 3, v18
    v_bfe_u32 v19, v0, 3, 1
    v_lshl_add_u32 v18, v19, 2, v18
    v_sub_u32 v19, 32, v18
    s_waitcnt vmcnt(10)
    s_barrier
    v_cndmask_b32 v18, v18, v19, vcc
    v_lshrrev_b32 v19, 5, v18
    v_and_b32 v18, 31, v18
    v_lshlrev_b32 v18, 2, v18
    v_lshl_add_u32 v18, v19, 13, v18
    v_lshl_add_u32 v18, v17, 10, v18
    v_add_u32 v138, 147456, v18
    v_add_u32 v139, 128, v138
    s_waitcnt vmcnt(8)
    s_barrier
    s_cmp_eq_u32 s52, 1
    s_cbranch_scc0 sk_4
    s_mov_b32 s79, 16384
    s_mov_b32 s7, s6
kvp_5:
    s_waitcnt lgkmcnt(0)
    s_xor_b64 s[20:21], s[20:21], s[6:7]
    s_xor_b64 s[22:23], s[22:23], s[6:7]
    s_or_b64 s[20:21], s[20:21], s[22:23]
    s_xor_b64 s[24:25], s[24:25], s[6:7]
    s_or_b64 s[20:21], s[20:21], s[24:25]
    s_xor_b64 s[26:27], s[26:27], s[6:7]
    s_or_b64 s[20:21], s[20:21], s[26:27]
    s_xor_b64 s[28:29], s[28:29], s[6:7]
    s_or_b64 s[20:21], s[20:21], s[28:29]
    s_cbranch_scc0 kvp_5_d
    s_load_dwordx16 s[20:35], s[18:19], s77 glc
    s_sub_u32 s79, s79, 1
    s_cbranch_scc0 kvp_5
    s_waitcnt lgkmcnt(0)
kvp_5_d:
sk_4:
    s_waitcnt vmcnt(6)
    s_barrier
    s_add_u32 m0, s0, 135168
    s_mov_b32 exec_hi, 0x00ffffff
    buffer_load_dwordx4 v127, s[44:47], s8 offen offset:0 sc1 lds
    buffer_load_dwordx4 v127, s[44:47], s8 offen offset:896 sc1 lds
    s_mov_b32 exec_hi, -1
    s_add_u32 m0, s0, 128000
    s_mov_b32 exec_hi, 0x00ffffff
    buffer_load_dwordx4 v127, s[44:47], s15 offen offset:0 sc1 lds
    buffer_load_dwordx4 v127, s[44:47], s15 offen offset:896 sc1 lds
    s_mov_b32 exec_hi, -1
    s_waitcnt vmcnt(8)
    s_barrier
    s_add_u32 m0, s0, 120832
    s_mov_b32 exec_hi, 0x00ffffff
    buffer_load_dwordx4 v127, s[44:47], s14 offen offset:0 sc1 lds
    buffer_load_dwordx4 v127, s[44:47], s14 offen offset:896 sc1 lds
    s_mov_b32 exec_hi, -1
    s_waitcnt vmcnt(8)
    s_barrier
    s_mov_b64 exec, 0xfffff
    ds_write_b128 v132, v[128:131] offset:896
    s_mov_b64 exec, -1
L_p7join2:
    s_waitcnt vmcnt(6)
    s_barrier
    s_setprio 2
    s_cmp_eq_u32 s52, 1
    s_cbranch_scc0 sk_6
    s_lshr_b32 s7, s55, 3
    s_lshl3_add_u32 s3, s56, s7
    s_lshl_b32 s3, s3, 7
    s_and_b32 s7, s55, 7
    s_lshl2_add_u32 s3, s7, s3
    s_add_u32 s3, s3, 0x28000
    s_atomic_swap s6, s[18:19], s3
sk_6:
    s_add_u32 m0, s0, 113664
    s_mov_b32 exec_hi, 0x00ffffff
    buffer_load_dwordx4 v127, s[44:47], s13 offen offset:0 sc1 lds
    buffer_load_dwordx4 v127, s[44:47], s13 offen offset:896 sc1 lds
    s_mov_b32 exec_hi, -1
    s_add_u32 m0, s0, 106496
    s_mov_b32 exec_hi, 0x00ffffff
    buffer_load_dwordx4 v127, s[44:47], s12 offen offset:0 sc1 lds
    buffer_load_dwordx4 v127, s[44:47], s12 offen offset:896 sc1 lds
    s_mov_b32 exec_hi, -1
    s_lshl_b32 s3, s65, 13
    s_add_u32 m0, s3, s66
    s_mul_i32 s3, s65, 57344
    buffer_load_dwordx4 v12, s[36:39], s3 offen lds
    s_addk_i32 m0, 4096
    s_nop 0
    buffer_load_dwordx4 v13, s[36:39], s3 offen lds
    s_waitcnt vmcnt(6)
    s_barrier
    s_add_u32 s65, s65, 1
    s_cmp_eq_u32 s65, 7
    s_cselect_b32 s65, 0, s65
    s_lshl_b32 s3, s65, 13
    s_add_u32 m0, s3, s66
    s_mul_i32 s3, s65, 57344
    buffer_load_dwordx4 v12, s[36:39], s3 offen lds
    s_addk_i32 m0, 4096
    s_nop 0
    buffer_load_dwordx4 v13, s[36:39], s3 offen lds
    s_add_u32 s65, s65, 1
    s_cmp_eq_u32 s65, 7
    s_cselect_b32 s65, 0, s65
    s_lshl_b32 s3, s65, 13
    s_add_u32 m0, s3, s66
    s_mul_i32 s3, s65, 57344
    buffer_load_dwordx4 v12, s[36:39], s3 offen lds
    s_addk_i32 m0, 4096
    s_nop 0
    buffer_load_dwordx4 v13, s[36:39], s3 offen lds
    s_barrier
    s_cmp_eq_u32 s9, 0
    s_cbranch_scc0 sk_7
    s_atomic_swap s6, s[4:5], s24
    s_atomic_swap s6, s[4:5], s25
    s_atomic_swap s6, s[4:5], s26
    s_atomic_swap s6, s[4:5], s27
    s_atomic_swap s6, s[4:5], s11
sk_7:
    s_add_u32 s65, s65, 1
    s_cmp_eq_u32 s65, 7
    s_cselect_b32 s65, 0, s65
    s_lshl_b32 s3, s65, 13
    s_add_u32 m0, s3, s66
    s_mul_i32 s3, s65, 57344
    buffer_load_dwordx4 v12, s[36:39], s3 offen lds
    s_addk_i32 m0, 4096
    s_nop 0
    buffer_load_dwordx4 v13, s[36:39], s3 offen lds
    s_waitcnt vmcnt(8)
    s_barrier
    s_cmp_eq_u32 s52, 3
    s_cbranch_scc0 sk_8
    s_load_dwordx16 s[20:35], s[18:19], s77 glc
sk_8:
    s_add_u32 s65, s65, 1
    s_cmp_eq_u32 s65, 7
    s_cselect_b32 s65, 0, s65
    s_lshl_b32 s3, s65, 13
    s_add_u32 m0, s3, s66
    s_mul_i32 s3, s65, 57344
    buffer_load_dwordx4 v12, s[36:39], s3 offen lds
    s_addk_i32 m0, 4096
    s_nop 0
    buffer_load_dwordx4 v13, s[36:39], s3 offen lds
    s_add_u32 s65, s65, 1
    s_cmp_eq_u32 s65, 7
    s_cselect_b32 s65, 0, s65
    s_lshl_b32 s3, s65, 13
    s_add_u32 m0, s3, s66
    s_mul_i32 s3, s65, 57344
    buffer_load_dwordx4 v12, s[36:39], s3 offen lds
    s_addk_i32 m0, 4096
    s_nop 0
    buffer_load_dwordx4 v13, s[36:39], s3 offen lds
    s_add_u32 s65, s65, 1
    s_cmp_eq_u32 s65, 7
    s_cselect_b32 s65, 0, s65
    s_lshl_b32 s3, s65, 13
    s_add_u32 m0, s3, s66
    s_mul_i32 s3, s65, 57344
    buffer_load_dwordx4 v12, s[36:39], s3 offen lds
    s_addk_i32 m0, 4096
    s_nop 0
    buffer_load_dwordx4 v13, s[36:39], s3 offen lds
    s_cmp_eq_u32 s52, 2
    s_cbranch_scc1 L_roleT
    s_cmp_eq_u32 s52, 0
    s_cbranch_scc1 L_roleX
    s_cmp_eq_u32 s52, 1
    s_cbranch_scc1 L_pad_g1p2
    s_add_u32 s12, s12, 0x200000
    s_add_u32 s13, s13, 0x200000
    s_add_u32 s14, s14, 0x200000
    s_add_u32 s15, s15, 0x200000
    s_add_u32 s8, s8, 0x200000
    v_add_u32 v135, 3584, v14
    s_nop 0
    s_mov_b32 exec_hi, 0x00ffffff
    s_mov_b32 s79, 16384
    s_mov_b32 s7, s6
    s_waitcnt lgkmcnt(0)
    s_mov_b64 s[68:69], s[28:29]
    s_mov_b64 s[62:63], s[26:27]
    s_mov_b64 s[60:61], s[24:25]
    s_mov_b64 s[50:51], s[22:23]
    s_mov_b64 s[48:49], s[20:21]
    s_load_dwordx16 s[20:35], s[18:19], s77 glc
    s_cmp_eq_u64 s[48:49], s[6:7]
    s_cbranch_scc1 vg_9_d
vg_9:
    s_waitcnt lgkmcnt(0)
    s_mov_b64 s[68:69], s[28:29]
    s_mov_b64 s[62:63], s[26:27]
    s_mov_b64 s[60:61], s[24:25]
    s_mov_b64 s[50:51], s[22:23]
    s_mov_b64 s[48:49], s[20:21]
    s_load_dwordx16 s[20:35], s[18:19], s77 glc
    s_sub_u32 s79, s79, 1
    s_max_i32 s79, s79, 0
    s_cbranch_scc0 vg_9_d
    s_cmp_lg_u64 s[48:49], s[6:7]
    s_cbranch_scc1 vg_9
vg_9_d:
    s_mov_b32 m0, 32768
    s_nop 0
    buffer_load_dwordx4 v14, s[44:47], s8 offen offset:0 sc1 lds
    s_addk_i32 m0, 128
    s_nop 0
    buffer_load_dwordx4 v14, s[44:47], s8 offen offset:896 sc1 lds
    s_addk_i32 m0, 128
    s_nop 0
    buffer_load_dwordx4 v14, s[44:47], s8 offen offset:1792 sc1 lds
    s_addk_i32 m0, 128
    s_nop 0
    buffer_load_dwordx4 v14, s[44:47], s8 offen offset:2688 sc1 lds
    s_addk_i32 m0, 3712
    s_nop 0
    buffer_load_dwordx4 v135, s[44:47], s8 offen offset:0 sc1 lds
    s_addk_i32 m0, 128
    s_nop 0
    buffer_load_dwordx4 v135, s[44:47], s8 offen offset:896 sc1 lds
    s_addk_i32 m0, 128
    s_nop 0
    buffer_load_dwordx4 v135, s[44:47], s8 offen offset:1792 sc1 lds
    s_addk_i32 m0, 128
    s_nop 0
    buffer_load_dwordx4 v135, s[44:47], s8 offen offset:2688 sc1 lds
    s_cmp_eq_u64 s[50:51], s[6:7]
    s_cbranch_scc1 vg_10_d
vg_10:
    s_waitcnt lgkmcnt(0)
    s_mov_b64 s[68:69], s[28:29]
    s_mov_b64 s[62:63], s[26:27]
    s_mov_b64 s[60:61], s[24:25]
    s_mov_b64 s[50:51], s[22:23]
    s_load_dwordx16 s[20:35], s[18:19], s77 glc
    s_sub_u32 s79, s79, 1
    s_max_i32 s79, s79, 0
    s_cbranch_scc0 vg_10_d
    s_cmp_lg_u64 s[50:51], s[6:7]
    s_cbranch_scc1 vg_10
vg_10_d:
    s_mov_b32 m0, 24576
    s_nop 0
    buffer_load_dwordx4 v14, s[44:47], s15 offen offset:0 sc1 lds
    s_addk_i32 m0, 128
    s_nop 0
    buffer_load_dwordx4 v14, s[44:47], s15 offen offset:896 sc1 lds
    s_addk_i32 m0, 128
    s_nop 0
    buffer_load_dwordx4 v14, s[44:47], s15 offen offset:1792 sc1 lds
    s_addk_i32 m0, 128
    s_nop 0
    buffer_load_dwordx4 v14, s[44:47], s15 offen offset:2688 sc1 lds
    s_addk_i32 m0, 3712
    s_nop 0
    buffer_load_dwordx4 v135, s[44:47], s15 offen offset:0 sc1 lds
    s_addk_i32 m0, 128
    s_nop 0
    buffer_load_dwordx4 v135, s[44:47], s15 offen offset:896 sc1 lds
    s_addk_i32 m0, 128
    s_nop 0
    buffer_load_dwordx4 v135, s[44:47], s15 offen offset:1792 sc1 lds
    s_addk_i32 m0, 128
    s_nop 0
    buffer_load_dwordx4 v135, s[44:47], s15 offen offset:2688 sc1 lds
    s_cmp_eq_u64 s[60:61], s[6:7]
    s_cbranch_scc1 vg_11_d
vg_11:
    s_waitcnt lgkmcnt(0)
    s_mov_b64 s[68:69], s[28:29]
    s_mov_b64 s[62:63], s[26:27]
    s_mov_b64 s[60:61], s[24:25]
    s_load_dwordx16 s[20:35], s[18:19], s77 glc
    s_sub_u32 s79, s79, 1
    s_max_i32 s79, s79, 0
    s_cbranch_scc0 vg_11_d
    s_cmp_lg_u64 s[60:61], s[6:7]
    s_cbranch_scc1 vg_11
vg_11_d:
    s_mov_b32 m0, 16384
    s_nop 0
    buffer_load_dwordx4 v14, s[44:47], s14 offen offset:0 sc1 lds
    s_addk_i32 m0, 128
    s_nop 0
    buffer_load_dwordx4 v14, s[44:47], s14 offen offset:896 sc1 lds
    s_addk_i32 m0, 128
    s_nop 0
    buffer_load_dwordx4 v14, s[44:47], s14 offen offset:1792 sc1 lds
    s_addk_i32 m0, 128
    s_nop 0
    buffer_load_dwordx4 v14, s[44:47], s14 offen offset:2688 sc1 lds
    s_addk_i32 m0, 3712
    s_nop 0
    buffer_load_dwordx4 v135, s[44:47], s14 offen offset:0 sc1 lds
    s_addk_i32 m0, 128
    s_nop 0
    buffer_load_dwordx4 v135, s[44:47], s14 offen offset:896 sc1 lds
    s_addk_i32 m0, 128
    s_nop 0
    buffer_load_dwordx4 v135, s[44:47], s14 offen offset:1792 sc1 lds
    s_addk_i32 m0, 128
    s_nop 0
    buffer_load_dwordx4 v135, s[44:47], s14 offen offset:2688 sc1 lds
    s_cmp_eq_u64 s[62:63], s[6:7]
    s_cbranch_scc1 vg_12_d
vg_12:
    s_waitcnt lgkmcnt(0)
    s_mov_b64 s[68:69], s[28:29]
    s_mov_b64 s[62:63], s[26:27]
    s_load_dwordx16 s[20:35], s[18:19], s77 glc
    s_sub_u32 s79, s79, 1
    s_max_i32 s79, s79, 0
    s_cbranch_scc0 vg_12_d
    s_cmp_lg_u64 s[62:63], s[6:7]
    s_cbranch_scc1 vg_12
vg_12_d:
    s_mov_b32 m0, 8192
    s_nop 0
    buffer_load_dwordx4 v14, s[44:47], s13 offen offset:0 sc1 lds
    s_addk_i32 m0, 128
    s_nop 0
    buffer_load_dwordx4 v14, s[44:47], s13 offen offset:896 sc1 lds
    s_addk_i32 m0, 128
    s_nop 0
    buffer_load_dwordx4 v14, s[44:47], s13 offen offset:1792 sc1 lds
    s_addk_i32 m0, 128
    s_nop 0
    buffer_load_dwordx4 v14, s[44:47], s13 offen offset:2688 sc1 lds
    s_addk_i32 m0, 3712
    s_nop 0
    buffer_load_dwordx4 v135, s[44:47], s13 offen offset:0 sc1 lds
    s_addk_i32 m0, 128
    s_nop 0
    buffer_load_dwordx4 v135, s[44:47], s13 offen offset:896 sc1 lds
    s_addk_i32 m0, 128
    s_nop 0
    buffer_load_dwordx4 v135, s[44:47], s13 offen offset:1792 sc1 lds
    s_addk_i32 m0, 128
    s_nop 0
    buffer_load_dwordx4 v135, s[44:47], s13 offen offset:2688 sc1 lds
    s_cmp_eq_u64 s[68:69], s[6:7]
    s_cbranch_scc1 vg_13_d
vg_13:
    s_waitcnt lgkmcnt(0)
    s_mov_b64 s[68:69], s[28:29]
    s_load_dwordx16 s[20:35], s[18:19], s77 glc
    s_sub_u32 s79, s79, 1
    s_max_i32 s79, s79, 0
    s_cbranch_scc0 vg_13_d
    s_cmp_lg_u64 s[68:69], s[6:7]
    s_cbranch_scc1 vg_13
vg_13_d:
    s_mov_b32 m0, 0
    s_nop 0
    buffer_load_dwordx4 v14, s[44:47], s12 offen offset:0 sc1 lds
    s_addk_i32 m0, 128
    s_nop 0
    buffer_load_dwordx4 v14, s[44:47], s12 offen offset:896 sc1 lds
    s_addk_i32 m0, 128
    s_nop 0
    buffer_load_dwordx4 v14, s[44:47], s12 offen offset:1792 sc1 lds
    s_addk_i32 m0, 128
    s_nop 0
    buffer_load_dwordx4 v14, s[44:47], s12 offen offset:2688 sc1 lds
    s_addk_i32 m0, 3712
    s_nop 0
    buffer_load_dwordx4 v135, s[44:47], s12 offen offset:0 sc1 lds
    s_addk_i32 m0, 128
    s_nop 0
    buffer_load_dwordx4 v135, s[44:47], s12 offen offset:896 sc1 lds
    s_addk_i32 m0, 128
    s_nop 0
    buffer_load_dwordx4 v135, s[44:47], s12 offen offset:1792 sc1 lds
    s_addk_i32 m0, 128
    s_nop 0
    buffer_load_dwordx4 v135, s[44:47], s12 offen offset:2688 sc1 lds
    s_mov_b64 exec, -1
    s_waitcnt vmcnt(24)
    s_barrier
    s_waitcnt vmcnt(16)
    s_barrier
    s_waitcnt vmcnt(8)
    s_barrier
    s_waitcnt vmcnt(0)
    s_barrier
    s_branch L_a2
    .p2alignl 12, 0xbf810000
L_pad_roleT:
    s_branch L_hopret
L_roleT:
    v_lshrrev_b32 v18, 3, v0
    v_lshlrev_b32 v18, 7, v18
    v_and_b32 v19, 7, v0
    v_lshl_add_u32 v18, v19, 2, v18
    s_mov_b32 s75, 0x28000
    s_cmp_eq_u32 s54, 7
    s_cbranch_scc1 L_epoch
    s_lshr_b32 s3, s54, 1
    s_and_b32 s7, s54, 1
    v_lshl_add_u32 v18, s3, 10, v18
    v_lshl_add_u32 v19, s7, 10, v18
    s_mul_i32 s74, s53, 65920
    s_lshl_b32 s3, s54, 13
    s_add_u32 s74, s74, s3
    s_add_u32 s74, s74, 0x7f0000
    s_waitcnt lgkmcnt(0)
    s_mov_b32 s79, 0
poll_14:
    buffer_load_dword v20, v18, s[44:47], s75 offen offset:0 sc1
    buffer_load_dword v21, v19, s[44:47], s75 offen offset:0 sc1
    s_add_u32 s79, s79, 1
    s_cmp_gt_u32 s79, 16384
    s_cbranch_scc1 poll_14_d
    s_waitcnt vmcnt(0)
    v_cmp_ne_u32 vcc, s6, v20
    s_nop 0
    s_cbranch_vccnz poll_14
    v_cmp_ne_u32 vcc, s6, v21
    s_nop 0
    s_cbranch_vccnz poll_14
poll_14_d:
    s_barrier
    s_mov_b32 m0, 147456
    s_nop 0
    buffer_load_dwordx4 v14, s[44:47], s74 offen offset:0 sc1 lds
    buffer_load_dwordx4 v14, s[44:47], s74 offen offset:1024 sc1 lds
    buffer_load_dwordx4 v14, s[44:47], s74 offen offset:2048 sc1 lds
    buffer_load_dwordx4 v14, s[44:47], s74 offen offset:3072 sc1 lds
    s_mov_b32 m0, 151552
    s_add_u32 s74, s74, 4096
    buffer_load_dwordx4 v14, s[44:47], s74 offen offset:0 sc1 lds
    buffer_load_dwordx4 v14, s[44:47], s74 offen offset:1024 sc1 lds
    buffer_load_dwordx4 v14, s[44:47], s74 offen offset:2048 sc1 lds
    buffer_load_dwordx4 v14, s[44:47], s74 offen offset:3072 sc1 lds
    s_barrier
    s_mov_b32 m0, 155648
    s_add_u32 s74, s74, 4096
    buffer_load_dwordx4 v14, s[44:47], s74 offen offset:0 sc1 lds
    buffer_load_dwordx4 v14, s[44:47], s74 offen offset:1024 sc1 lds
    buffer_load_dwordx4 v14, s[44:47], s74 offen offset:2048 sc1 lds
    buffer_load_dwordx4 v14, s[44:47], s74 offen offset:3072 sc1 lds
    s_mov_b32 m0, 159744
    s_add_u32 s74, s74, 4096
    buffer_load_dwordx4 v14, s[44:47], s74 offen offset:0 sc1 lds
    buffer_load_dwordx4 v14, s[44:47], s74 offen offset:1024 sc1 lds
    buffer_load_dwordx4 v14, s[44:47], s74 offen offset:2048 sc1 lds
    buffer_load_dwordx4 v14, s[44:47], s74 offen offset:3072 sc1 lds
    s_barrier
    s_barrier
    s_branch L_a2
L_roleX:
    s_waitcnt lgkmcnt(0)
    s_load_dwordx8 s[20:27], s[18:19], s76 glc
    s_mov_b32 s79, 16384
xm_15:
    s_waitcnt lgkmcnt(0)
    s_cmp_lg_u64 s[20:21], s[16:17]
    s_cbranch_scc1 xm_15_n
    s_cmp_lg_u64 s[22:23], s[16:17]
    s_cbranch_scc1 xm_15_n
    s_cmp_lg_u64 s[24:25], s[16:17]
    s_cbranch_scc1 xm_15_n
    s_cmp_lg_u64 s[26:27], s[16:17]
    s_cbranch_scc1 xm_15_n
    v_mov_b32 v21, 1
xm_15_e:
    ds_write_b32 v15, v21 offset:12
    s_waitcnt lgkmcnt(0)
L_rolesdone:
    s_waitcnt vmcnt(0) lgkmcnt(0)
    s_barrier
    s_barrier
    s_barrier
    s_barrier
L_a2:
    s_setprio 0
    s_cmp_eq_u32 s54, 7
    s_cbranch_scc1 L_g2end
    ds_read_b128 v[80:83], v134 offset:0
    ds_read_b128 v[84:87], v134 offset:1024
    ds_read_b128 v[88:91], v134 offset:2048
    ds_read_b128 v[92:95], v134 offset:3072
    ds_read_b128 v[96:99], v134 offset:4096
    ds_read_b128 v[100:103], v134 offset:5120
    ds_read_b128 v[104:107], v134 offset:6144
    ds_read_b128 v[108:111], v134 offset:7168
    ds_read_b64_tr_b16 v[144:145], v120 offset:0
    ds_read_b64_tr_b16 v[146:147], v120 offset:512
    ds_read_b64_tr_b16 v[148:149], v120 offset:2048
    ds_read_b64_tr_b16 v[150:151], v120 offset:2560
    ds_read_b64_tr_b16 v[152:153], v120 offset:4096
    ds_read_b64_tr_b16 v[154:155], v120 offset:4608
    ds_read_b64_tr_b16 v[156:157], v120 offset:6144
    ds_read_b64_tr_b16 v[158:159], v120 offset:6656
    ds_read_b64_tr_b16 v[160:161], v120 offset:8192
    ds_read_b64_tr_b16 v[162:163], v120 offset:8704
    ds_read_b64_tr_b16 v[164:165], v120 offset:10240
    ds_read_b64_tr_b16 v[166:167], v120 offset:10752
    ds_read_b64_tr_b16 v[168:169], v120 offset:12288
    ds_read_b64_tr_b16 v[170:171], v120 offset:12800
    ds_read_b64_tr_b16 v[172:173], v120 offset:14336
    ds_read_b64_tr_b16 v[174:175], v120 offset:14848
    s_mul_i32 s3, s57, 0x80008000
    s_waitcnt lgkmcnt(0)
    v_xor_b32 v96, s3, v96
    v_xor_b32 v97, s3, v97
    v_xor_b32 v98, s3, v98
    v_xor_b32 v99, s3, v99
    v_xor_b32 v100, s3, v100
    v_xor_b32 v101, s3, v101
    v_xor_b32 v102, s3, v102
    v_xor_b32 v103, s3, v103
    v_xor_b32 v104, s3, v104
    v_xor_b32 v105, s3, v105
    v_xor_b32 v106, s3, v106
    v_xor_b32 v107, s3, v107
    v_xor_b32 v108, s3, v108
    v_xor_b32 v109, s3, v109
    v_xor_b32 v110, s3, v110
    v_xor_b32 v111, s3, v111
    s_waitcnt vmcnt(0)
    s_barrier
    ds_read2st64_b32 v[32:33], v138 offset0:0 offset1:1
    ds_read2st64_b32 v[34:35], v138 offset0:2 offset1:3
    ds_read2st64_b32 v[36:37], v138 offset0:8 offset1:9
    ds_read2st64_b32 v[38:39], v138 offset0:10 offset1:11
    ds_read2st64_b32 v[40:41], v138 offset0:16 offset1:17
    ds_read2st64_b32 v[42:43], v138 offset0:18 offset1:19
    ds_read2st64_b32 v[44:45], v138 offset0:24 offset1:25
    ds_read2st64_b32 v[46:47], v138 offset0:26 offset1:27
    ds_read2st64_b32 v[48:49], v139 offset0:0 offset1:1
    ds_read2st64_b32 v[50:51], v139 offset0:2 offset1:3
    ds_read2st64_b32 v[52:53], v139 offset0:8 offset1:9
    ds_read2st64_b32 v[54:55], v139 offset0:10 offset1:11
    s_waitcnt lgkmcnt(10)
    v_mfma_f32_32x32x16_bf16 v[64:79], v[32:35], v[80:83], 0
    ds_read2st64_b32 v[56:57], v139 offset0:16 offset1:17
    ds_read2st64_b32 v[58:59], v139 offset0:18 offset1:19
    s_waitcnt lgkmcnt(10)
    v_mfma_f32_32x32x16_bf16 v[64:79], v[36:39], v[84:87], v[64:79]
    ds_read2st64_b32 v[60:61], v139 offset0:24 offset1:25
    ds_read2st64_b32 v[62:63], v139 offset0:26 offset1:27
    s_waitcnt lgkmcnt(10)
    v_mfma_f32_32x32x16_bf16 v[64:79], v[40:43], v[88:91], v[64:79]
    s_waitcnt lgkmcnt(8)
    v_mfma_f32_32x32x16_bf16 v[64:79], v[44:47], v[92:95], v[64:79]
    s_waitcnt lgkmcnt(6)
    v_mfma_f32_32x32x16_bf16 v[64:79], v[48:51], v[96:99], v[64:79]
    s_waitcnt lgkmcnt(4)
    v_mfma_f32_32x32x16_bf16 v[64:79], v[52:55], v[100:103], v[64:79]
    s_waitcnt lgkmcnt(2)
    v_mfma_f32_32x32x16_bf16 v[64:79], v[56:59], v[104:107], v[64:79]
    s_waitcnt lgkmcnt(0)
    v_mfma_f32_32x32x16_bf16 v[64:79], v[60:63], v[108:111], v[64:79]
    s_nop 11
    v_cvt_pk_bf16_f32 v24, v64, v65
    v_cvt_pk_bf16_f32 v25, v66, v67
    v_cvt_pk_bf16_f32 v26, v68, v69
    v_cvt_pk_bf16_f32 v27, v70, v71
    ds_write_b128 v122, v[24:27]
    v_cvt_pk_bf16_f32 v28, v72, v73
    v_cvt_pk_bf16_f32 v29, v74, v75
    v_cvt_pk_bf16_f32 v30, v76, v77
    v_cvt_pk_bf16_f32 v31, v78, v79
    ds_write_b128 v123, v[28:31]
    ds_read_b128 v[112:115], v121
    ds_read_b128 v[116:119], v121 offset:1024
    ds_read_b64_tr_b16 v[176:177], v120 offset:16384
    ds_read_b64_tr_b16 v[178:179], v120 offset:16896
    ds_read_b64_tr_b16 v[180:181], v120 offset:18432
    ds_read_b64_tr_b16 v[182:183], v120 offset:18944
    ds_read_b64_tr_b16 v[184:185], v120 offset:20480
    ds_read_b64_tr_b16 v[186:187], v120 offset:20992
    ds_read_b64_tr_b16 v[188:189], v120 offset:22528
    ds_read_b64_tr_b16 v[190:191], v120 offset:23040
    ds_read_b64_tr_b16 v[192:193], v120 offset:24576
    ds_read_b64_tr_b16 v[194:195], v120 offset:25088
    ds_read_b64_tr_b16 v[196:197], v120 offset:26624
    ds_read_b64_tr_b16 v[198:199], v120 offset:27136
    ds_read_b64_tr_b16 v[200:201], v120 offset:28672
    ds_read_b64_tr_b16 v[202:203], v120 offset:29184
    ds_read_b64_tr_b16 v[204:205], v120 offset:30720
    ds_read_b64_tr_b16 v[206:207], v120 offset:31232
    ds_read_b64_tr_b16 v[208:209], v120 offset:32768
    ds_read_b64_tr_b16 v[210:211], v120 offset:33280
    ds_read_b64_tr_b16 v[212:213], v120 offset:34816
    ds_read_b64_tr_b16 v[214:215], v120 offset:35328
    ds_read_b64_tr_b16 v[216:217], v120 offset:36864
    ds_read_b64_tr_b16 v[218:219], v120 offset:37376
    ds_read_b64_tr_b16 v[220:221], v120 offset:38912
    ds_read_b64_tr_b16 v[222:223], v120 offset:39424
    ds_read_b64_tr_b16 v[224:225], v120 offset:40960
    ds_read_b64_tr_b16 v[226:227], v120 offset:41472
    ds_read_b64_tr_b16 v[228:229], v120 offset:43008
    ds_read_b64_tr_b16 v[230:231], v120 offset:43520
    ds_read_b64_tr_b16 v[232:233], v120 offset:45056
    ds_read_b64_tr_b16 v[234:235], v120 offset:45568
    ds_read_b64_tr_b16 v[236:237], v120 offset:47104
    ds_read_b64_tr_b16 v[238:239], v120 offset:47616
    ds_read_b64_tr_b16 v[240:241], v120 offset:49152
    ds_read_b64_tr_b16 v[242:243], v120 offset:49664
    ds_read_b64_tr_b16 v[244:245], v120 offset:51200
    ds_read_b64_tr_b16 v[246:247], v120 offset:51712
    ds_read_b64_tr_b16 v[248:249], v120 offset:53248
    ds_read_b64_tr_b16 v[250:251], v120 offset:53760
    ds_read_b64_tr_b16 v[252:253], v120 offset:55296
    ds_read_b64_tr_b16 v[254:255], v120 offset:55808
    s_setprio 2
    s_waitcnt lgkmcnt(0)
    s_barrier
    ds_read_b64 v[32:33], v126 offset:0
    ds_read_b64 v[34:35], v126 offset:256
    ds_read_b64 v[36:37], v126 offset:1024
    ds_read_b64 v[38:39], v126 offset:1280
    ds_read_b64 v[40:41], v126 offset:2048
    ds_read_b64 v[42:43], v126 offset:2304
    ds_read_b64 v[44:45], v126 offset:3072
    ds_read_b64 v[46:47], v126 offset:3328
    s_waitcnt lgkmcnt(6)
    v_mfma_f32_32x32x16_bf16 v[64:79], v[144:147], v[32:35], 0
    s_barrier
    s_waitcnt lgkmcnt(4)
    v_mfma_f32_32x32x16_bf16 v[64:79], v[148:151], v[36:39], v[64:79]
    ds_read_b64 v[48:49], v126 offset:8192
    ds_read_b64 v[50:51], v126 offset:8448
    s_waitcnt lgkmcnt(4)
    v_mfma_f32_32x32x16_bf16 v[64:79], v[152:155], v[40:43], v[64:79]
    ds_read_b64 v[52:53], v126 offset:9216
    ds_read_b64 v[54:55], v126 offset:9472
    s_waitcnt lgkmcnt(4)
    v_mfma_f32_32x32x16_bf16 v[64:79], v[156:159], v[44:47], v[64:79]
    ds_read_b64 v[56:57], v126 offset:10240
    ds_read_b64 v[58:59], v126 offset:10496
    ds_read_b64 v[60:61], v126 offset:11264
    ds_read_b64 v[62:63], v126 offset:11520
    s_waitcnt lgkmcnt(6)
    v_mfma_f32_32x32x16_bf16 v[64:79], v[160:163], v[48:51], v[64:79]
    s_barrier
    s_waitcnt lgkmcnt(4)
    v_mfma_f32_32x32x16_bf16 v[64:79], v[164:167], v[52:55], v[64:79]
    ds_read_b64 v[32:33], v126 offset:16384
    ds_read_b64 v[34:35], v126 offset:16640
    s_waitcnt lgkmcnt(4)
    v_mfma_f32_32x32x16_bf16 v[64:79], v[168:171], v[56:59], v[64:79]
    ds_read_b64 v[36:37], v126 offset:17408
    ds_read_b64 v[38:39], v126 offset:17664
    s_waitcnt lgkmcnt(4)
    v_mfma_f32_32x32x16_bf16 v[64:79], v[172:175], v[60:63], v[64:79]
    ds_read_b64 v[40:41], v126 offset:18432
    ds_read_b64 v[42:43], v126 offset:18688
    ds_read_b64 v[44:45], v126 offset:19456
    ds_read_b64 v[46:47], v126 offset:19712
    s_waitcnt lgkmcnt(6)
    v_mfma_f32_32x32x16_bf16 v[64:79], v[176:179], v[32:35], v[64:79]
    s_barrier
    s_waitcnt lgkmcnt(4)
    v_mfma_f32_32x32x16_bf16 v[64:79], v[180:183], v[36:39], v[64:79]
    ds_read_b64 v[48:49], v126 offset:24576
    ds_read_b64 v[50:51], v126 offset:24832
    s_waitcnt lgkmcnt(4)
    v_mfma_f32_32x32x16_bf16 v[64:79], v[184:187], v[40:43], v[64:79]
    ds_read_b64 v[52:53], v126 offset:25600
    ds_read_b64 v[54:55], v126 offset:25856
    s_waitcnt lgkmcnt(4)
    v_mfma_f32_32x32x16_bf16 v[64:79], v[188:191], v[44:47], v[64:79]
    ds_read_b64 v[56:57], v126 offset:26624
    ds_read_b64 v[58:59], v126 offset:26880
    ds_read_b64 v[60:61], v126 offset:27648
    ds_read_b64 v[62:63], v126 offset:27904
    s_waitcnt lgkmcnt(6)
    v_mfma_f32_32x32x16_bf16 v[64:79], v[192:195], v[48:51], v[64:79]
    s_barrier
    s_waitcnt lgkmcnt(4)
    v_mfma_f32_32x32x16_bf16 v[64:79], v[196:199], v[52:55], v[64:79]
    ds_read_b64 v[32:33], v126 offset:32768
    ds_read_b64 v[34:35], v126 offset:33024
    s_waitcnt lgkmcnt(4)
    v_mfma_f32_32x32x16_bf16 v[64:79], v[200:203], v[56:59], v[64:79]
    ds_read_b64 v[36:37], v126 offset:33792
    ds_read_b64 v[38:39], v126 offset:34048
    s_waitcnt lgkmcnt(4)
    v_mfma_f32_32x32x16_bf16 v[64:79], v[204:207], v[60:63], v[64:79]
    ds_read_b64 v[40:41], v126 offset:34816
    ds_read_b64 v[42:43], v126 offset:35072
    ds_read_b64 v[44:45], v126 offset:35840
    ds_read_b64 v[46:47], v126 offset:36096
    s_waitcnt lgkmcnt(6)
    v_mfma_f32_32x32x16_bf16 v[64:79], v[208:211], v[32:35], v[64:79]
    s_barrier
    s_waitcnt lgkmcnt(4)
    v_mfma_f32_32x32x16_bf16 v[64:79], v[212:215], v[36:39], v[64:79]
    v_add_u32 v126, 0x1a000, v126
    ds_read_b64 v[48:49], v126 offset:0
    ds_read_b64 v[50:51], v126 offset:256
    s_waitcnt lgkmcnt(4)
    v_mfma_f32_32x32x16_bf16 v[64:79], v[216:219], v[40:43], v[64:79]
    ds_read_b64 v[52:53], v126 offset:1024
    ds_read_b64 v[54:55], v126 offset:1280
    s_waitcnt lgkmcnt(4)
    v_mfma_f32_32x32x16_bf16 v[64:79], v[220:223], v[44:47], v[64:79]
    ds_read_b64 v[56:57], v126 offset:2048
    ds_read_b64 v[58:59], v126 offset:2304
    ds_read_b64 v[60:61], v126 offset:3072
    ds_read_b64 v[62:63], v126 offset:3328
    s_waitcnt lgkmcnt(6)
    v_mfma_f32_32x32x16_bf16 v[64:79], v[224:227], v[48:51], v[64:79]
    buffer_store_dwordx4 v[112:115], v136, s[40:43], s64 offen nt
    s_barrier
    s_waitcnt lgkmcnt(4)
    v_mfma_f32_32x32x16_bf16 v[64:79], v[228:231], v[52:55], v[64:79]
    ds_read_b64 v[32:33], v126 offset:8192
    ds_read_b64 v[34:35], v126 offset:8448
    s_waitcnt lgkmcnt(4)
    v_mfma_f32_32x32x16_bf16 v[64:79], v[232:235], v[56:59], v[64:79]
    ds_read_b64 v[36:37], v126 offset:9216
    ds_read_b64 v[38:39], v126 offset:9472
    s_waitcnt lgkmcnt(4)
    v_mfma_f32_32x32x16_bf16 v[64:79], v[236:239], v[60:63], v[64:79]
    ds_read_b64 v[40:41], v126 offset:10240
    ds_read_b64 v[42:43], v126 offset:10496
    ds_read_b64 v[44:45], v126 offset:11264
    ds_read_b64 v[46:47], v126 offset:11520
    s_waitcnt lgkmcnt(6)
    v_mfma_f32_32x32x16_bf16 v[64:79], v[240:243], v[32:35], v[64:79]
    buffer_store_dwordx4 v[116:119], v137, s[40:43], s64 offen nt
    s_waitcnt lgkmcnt(4)
    v_mfma_f32_32x32x16_bf16 v[64:79], v[244:247], v[36:39], v[64:79]
    s_waitcnt lgkmcnt(2)
    v_mfma_f32_32x32x16_bf16 v[64:79], v[248:251], v[40:43], v[64:79]
    s_waitcnt lgkmcnt(0)
    v_mfma_f32_32x32x16_bf16 v[64:79], v[252:255], v[44:47], v[64:79]
    s_nop 11
    v_cvt_pk_bf16_f32 v24, v64, v65
    v_cvt_pk_bf16_f32 v25, v66, v67
    v_cvt_pk_bf16_f32 v26, v68, v69
    v_cvt_pk_bf16_f32 v27, v70, v71
    ds_write_b128 v122, v[24:27]
    v_cvt_pk_bf16_f32 v28, v72, v73
    v_cvt_pk_bf16_f32 v29, v74, v75
    v_cvt_pk_bf16_f32 v30, v76, v77
    v_cvt_pk_bf16_f32 v31, v78, v79
    ds_write_b128 v123, v[28:31]
    ds_read_b128 v[24:27], v121
    ds_read_b128 v[28:31], v121 offset:1024
    s_waitcnt lgkmcnt(1)
    buffer_store_dwordx4 v[24:27], v124, s[40:43], s10 offen nt
    s_waitcnt lgkmcnt(0)
    buffer_store_dwordx4 v[28:31], v125, s[40:43], s10 offen nt
L_g2end:
    s_endpgm
L_p7:
    s_add_u32 m0, s78, 32768
    s_nop 0
    buffer_load_dwordx4 v1, s[20:23], s62 offen lds
    s_add_u32 m0, s78, 36864
    s_nop 0
    buffer_load_dwordx4 v2, s[20:23], s62 offen lds
    s_add_u32 m0, s78, 49152
    s_nop 0
    buffer_load_dwordx4 v1, s[20:23], s63 offen lds
    s_add_u32 m0, s78, 53248
    s_nop 0
    buffer_load_dwordx4 v2, s[20:23], s63 offen lds
    v_lshlrev_b32 v14, 4, v0
    s_mul_i32 s0, s52, 1792
    v_add_u32 v127, s0, v14
    s_nop 0
    s_nop 0
    s_lshl3_add_u32 s3, s53, s54
    s_lshl_b32 s3, s3, 7
    s_mul_i32 s7, s58, 0x8000
    s_add_u32 s3, s3, s7
    s_add_u32 s77, s3, 0x10000
    s_mul_i32 s75, s54, 229376
    s_mul_i32 s3, s53, 7168
    s_add_u32 s3, s3, s75
    s_add_u32 s8, s3, 0x201000
    s_sub_u32 s3, s8, 28672
    s_cmp_lt_u32 s53, 4
    s_cselect_b32 s12, s46, s3
    s_sub_u32 s3, s8, 21504
    s_cmp_lt_u32 s53, 3
    s_cselect_b32 s13, s46, s3
    s_sub_u32 s3, s8, 14336
    s_cmp_lt_u32 s53, 2
    s_cselect_b32 s14, s46, s3
    s_sub_u32 s3, s8, 7168
    s_cmp_lt_u32 s53, 1
    s_cselect_b32 s15, s46, s3
    s_mul_i32 s3, s52, 10
    v_lshrrev_b32 v132, 1, v0
    v_add_u32 v132, s3, v132
    v_lshl_add_u32 v133, s53, 3, v132
    v_cmp_le_u32 vcc, 32, v133
    v_mov_b32 v129, 0x3f803f80
    v_and_b32 v133, 1, v0
    v_cndmask_b32 v128, 0, v129, vcc
    v_lshlrev_b32 v133, 6, v133
    v_lshl_add_u32 v132, v132, 10, v133
    v_mov_b32 v129, v128
    v_mov_b32 v130, v128
    v_mov_b32 v131, v128
    v_add_u32 v134, 98304, v14
    s_add_u32 s3, s54, s58
    s_and_b32 s3, s3, 7
    s_lshl_b32 s3, s3, 5
    s_sub_u32 s3, s3, s58
    s_lshl2_add_u32 s3, s3, 0x10004
    s_add_u32 s7, s53, 0
    s_and_b32 s7, s7, 31
    s_lshl_b32 s7, s7, 10
    s_add_u32 s24, s7, s3
    s_add_u32 s3, s3, 8
    s_add_u32 s7, s53, 1
    s_and_b32 s7, s7, 31
    s_lshl_b32 s7, s7, 10
    s_add_u32 s25, s7, s3
    s_add_u32 s3, s3, 8
    s_add_u32 s7, s53, 2
    s_and_b32 s7, s7, 31
    s_lshl_b32 s7, s7, 10
    s_add_u32 s26, s7, s3
    s_add_u32 s3, s3, 8
    s_add_u32 s7, s53, 3
    s_and_b32 s7, s7, 31
    s_lshl_b32 s7, s7, 10
    s_add_u32 s27, s7, s3
    s_add_u32 s3, s3, 8
    s_add_u32 s7, s53, 4
    s_and_b32 s7, s7, 31
    s_lshl_b32 s7, s7, 10
    s_add_u32 s11, s7, s3
    s_add_u32 s3, s3, 8
    s_add_u32 s4, s18, 0x8000
    s_addc_u32 s5, s19, 0
    s_lshl1_add_u32 s3, s78, 98304
    v_lshl_add_u32 v121, v0, 4, s3
    v_and_b32 v18, 15, v0
    v_lshl_add_u32 v19, v18, 6, s3
    v_lshrrev_b32 v18, 3, v0
    v_xor_b32 v20, v18, v0
    v_bfe_u32 v21, v20, 1, 2
    v_lshl_add_u32 v140, v21, 4, v19
    v_and_b32 v20, 3, v20
    v_lshlrev_b32 v142, 4, v20
    v_lshrrev_b32 v143, 2, v0
    v_mul_u32_u24 v18, 65920, v143
    v_add_u32 v141, v18, v142
    s_lshl1_add_u32 s3, s56, s58
    s_lshl_b32 s3, s3, 13
    s_lshl1_add_u32 s7, s55, s57
    s_lshl_b32 s7, s7, 6
    s_add_u32 s3, s3, s7
    s_add_u32 s74, s3, 0x7f0000
    s_cmp_eq_u32 s9, 1
    s_cbranch_scc0 sk_16
    s_atomic_swap s6, s[18:19], s24
    s_atomic_swap s6, s[18:19], s25
    s_atomic_swap s6, s[18:19], s26
    s_atomic_swap s6, s[18:19], s27
    s_atomic_swap s6, s[18:19], s11
    s_atomic_swap s6, s[4:5], s24
    s_atomic_swap s6, s[4:5], s25
    s_atomic_swap s6, s[4:5], s26
    s_atomic_swap s6, s[4:5], s27
    s_atomic_swap s6, s[4:5], s11
sk_16:
    s_add_u32 m0, s78, 65536
    s_nop 0
    buffer_load_dwordx4 v1, s[20:23], s64 offen lds
    s_add_u32 m0, s78, 69632
    s_nop 0
    buffer_load_dwordx4 v2, s[20:23], s64 offen lds
    s_add_u32 m0, s78, 81920
    s_nop 0
    buffer_load_dwordx4 v1, s[20:23], s65 offen lds
    s_add_u32 m0, s78, 86016
    s_nop 0
    buffer_load_dwordx4 v2, s[20:23], s65 offen lds
    s_add_u32 m0, s78, 98304
    s_nop 0
    buffer_load_dwordx4 v1, s[20:23], s66 offen lds
    s_add_u32 m0, s78, 102400
    s_nop 0
    buffer_load_dwordx4 v2, s[20:23], s66 offen lds
    s_add_u32 m0, s78, 114688
    s_nop 0
    buffer_load_dwordx4 v7, s[32:35], 0 offen offset:0 lds
    s_add_u32 m0, s78, 118656
    s_nop 0
    buffer_load_dwordx4 v7, s[32:35], 0 offen offset:128 lds
    s_add_u32 m0, s78, 122624
    s_nop 0
    buffer_load_dwordx4 v7, s[32:35], 0 offen offset:256 lds
    s_add_u32 m0, s78, 126592
    s_nop 0
    buffer_load_dwordx4 v7, s[32:35], 0 offen offset:384 lds
    s_add_u32 m0, s78, 130560
    s_nop 0
    buffer_load_dwordx4 v7, s[32:35], 0 offen offset:512 lds
    s_add_u32 m0, s78, 134528
    s_nop 0
    buffer_load_dwordx4 v7, s[32:35], 0 offen offset:640 lds
    s_add_u32 m0, s78, 138496
    s_nop 0
    buffer_load_dwordx4 v7, s[32:35], 0 offen offset:768 lds
    s_waitcnt vmcnt(7)
    s_barrier
    s_add_u32 m0, s78, 147456
    s_nop 0
    buffer_load_dwordx4 v5, s[48:51], s67 offen lds
    s_addk_i32 m0, 4096
    s_nop 0
    buffer_load_dwordx4 v6, s[48:51], s67 offen lds
    s_add_u32 m0, s78, 155648
    s_nop 0
    buffer_load_dwordx4 v5, s[48:51], s68 offen lds
    s_addk_i32 m0, 4096
    s_nop 0
    buffer_load_dwordx4 v6, s[48:51], s68 offen lds
    s_waitcnt lgkmcnt(0)
    s_waitcnt vmcnt(4)
    s_barrier
    ds_read_b128 v[24:27], v8 offset:0
    ds_read_b128 v[28:31], v8 offset:2048
    ds_read_b128 v[32:35], v9 offset:0
    ds_read_b128 v[36:39], v9 offset:2048
    ds_read_b128 v[40:43], v8 offset:4096
    ds_read_b128 v[44:47], v8 offset:6144
    ds_read_b128 v[48:51], v9 offset:4096
    ds_read_b128 v[52:55], v9 offset:6144
    ds_read_b128 v[56:59], v8 offset:8192
    ds_read_b128 v[60:63], v8 offset:10240
    s_waitcnt lgkmcnt(8)
    v_mfma_f32_16x16x32_bf16 v[64:67], v[24:27], v[144:147], 0
    v_mfma_f32_16x16x32_bf16 v[72:75], v[24:27], v[172:175], 0
    ds_read_b128 v[112:115], v9 offset:8192
    ds_read_b128 v[116:119], v9 offset:10240
    v_mfma_f32_16x16x32_bf16 v[68:71], v[28:31], v[144:147], 0
    v_mfma_f32_16x16x32_bf16 v[76:79], v[28:31], v[172:175], 0
    s_waitcnt lgkmcnt(8)
    v_mfma_f32_16x16x32_bf16 v[64:67], v[32:35], v[148:151], v[64:67]
    v_mfma_f32_16x16x32_bf16 v[72:75], v[32:35], v[176:179], v[72:75]
    ds_read_b128 v[24:27], v8 offset:12288
    ds_read_b128 v[28:31], v8 offset:14336
    v_mfma_f32_16x16x32_bf16 v[68:71], v[36:39], v[148:151], v[68:71]
    v_mfma_f32_16x16x32_bf16 v[76:79], v[36:39], v[176:179], v[76:79]
    s_waitcnt lgkmcnt(8)
    v_mfma_f32_16x16x32_bf16 v[64:67], v[40:43], v[152:155], v[64:67]
    v_mfma_f32_16x16x32_bf16 v[72:75], v[40:43], v[180:183], v[72:75]
    ds_read_b128 v[32:35], v9 offset:12288
    ds_read_b128 v[36:39], v9 offset:14336
    v_mfma_f32_16x16x32_bf16 v[68:71], v[44:47], v[152:155], v[68:71]
    v_mfma_f32_16x16x32_bf16 v[76:79], v[44:47], v[180:183], v[76:79]
    s_barrier
    s_add_u32 m0, s78, 0
    s_nop 0
    buffer_load_dwordx4 v5, s[48:51], s69 offen lds
    s_addk_i32 m0, 4096
    s_nop 0
    buffer_load_dwordx4 v6, s[48:51], s69 offen lds
    s_waitcnt lgkmcnt(8)
    v_mfma_f32_16x16x32_bf16 v[64:67], v[48:51], v[156:159], v[64:67]
    v_mfma_f32_16x16x32_bf16 v[72:75], v[48:51], v[184:187], v[72:75]
    ds_read_b128 v[40:43], v8 offset:16384
    ds_read_b128 v[44:47], v8 offset:18432
    v_mfma_f32_16x16x32_bf16 v[68:71], v[52:55], v[156:159], v[68:71]
    v_mfma_f32_16x16x32_bf16 v[76:79], v[52:55], v[184:187], v[76:79]
    s_waitcnt lgkmcnt(8)
    v_mfma_f32_16x16x32_bf16 v[64:67], v[56:59], v[160:163], v[64:67]
    v_mfma_f32_16x16x32_bf16 v[72:75], v[56:59], v[188:191], v[72:75]
    ds_read_b128 v[48:51], v9 offset:16384
    ds_read_b128 v[52:55], v9 offset:18432
    v_mfma_f32_16x16x32_bf16 v[68:71], v[60:63], v[160:163], v[68:71]
    v_mfma_f32_16x16x32_bf16 v[76:79], v[60:63], v[188:191], v[76:79]
    s_waitcnt lgkmcnt(8)
    v_mfma_f32_16x16x32_bf16 v[64:67], v[112:115], v[164:167], v[64:67]
    v_mfma_f32_16x16x32_bf16 v[72:75], v[112:115], v[192:195], v[72:75]
    ds_read_b128 v[56:59], v8 offset:20480
    ds_read_b128 v[60:63], v8 offset:22528
    v_mfma_f32_16x16x32_bf16 v[68:71], v[116:119], v[164:167], v[68:71]
    v_mfma_f32_16x16x32_bf16 v[76:79], v[116:119], v[192:195], v[76:79]
    s_add_u32 m0, s78, 8192
    s_nop 0
    buffer_load_dwordx4 v5, s[48:51], s70 offen lds
    s_addk_i32 m0, 4096
    s_nop 0
    buffer_load_dwordx4 v6, s[48:51], s70 offen lds
    s_waitcnt lgkmcnt(8)
    v_mfma_f32_16x16x32_bf16 v[64:67], v[24:27], v[168:171], v[64:67]
    v_mfma_f32_16x16x32_bf16 v[72:75], v[24:27], v[196:199], v[72:75]
    ds_read_b128 v[112:115], v9 offset:20480
    ds_read_b128 v[116:119], v9 offset:22528
    v_mfma_f32_16x16x32_bf16 v[68:71], v[28:31], v[168:171], v[68:71]
    v_mfma_f32_16x16x32_bf16 v[76:79], v[28:31], v[196:199], v[76:79]
    s_waitcnt lgkmcnt(8)
    v_mfma_f32_16x16x32_bf16 v[200:203], v[32:35], v[144:147], 0
    v_mfma_f32_16x16x32_bf16 v[208:211], v[32:35], v[172:175], 0
    ds_read_b128 v[24:27], v8 offset:24576
    ds_read_b128 v[28:31], v8 offset:26624
    v_mfma_f32_16x16x32_bf16 v[204:207], v[36:39], v[144:147], 0
    v_mfma_f32_16x16x32_bf16 v[212:215], v[36:39], v[172:175], 0
    s_waitcnt lgkmcnt(8)
    v_mfma_f32_16x16x32_bf16 v[200:203], v[40:43], v[148:151], v[200:203]
    v_mfma_f32_16x16x32_bf16 v[208:211], v[40:43], v[176:179], v[208:211]
    ds_read_b128 v[32:35], v9 offset:24576
    ds_read_b128 v[36:39], v9 offset:26624
    v_mfma_f32_16x16x32_bf16 v[204:207], v[44:47], v[148:151], v[204:207]
    v_mfma_f32_16x16x32_bf16 v[212:215], v[44:47], v[176:179], v[212:215]
    s_add_u32 m0, s78, 16384
    s_nop 0
    buffer_load_dwordx4 v5, s[48:51], s71 offen lds
    s_addk_i32 m0, 4096
    s_nop 0
    buffer_load_dwordx4 v6, s[48:51], s71 offen lds
    s_waitcnt lgkmcnt(8)
    v_mfma_f32_16x16x32_bf16 v[200:203], v[48:51], v[152:155], v[200:203]
    v_mfma_f32_16x16x32_bf16 v[208:211], v[48:51], v[180:183], v[208:211]
    v_mfma_f32_16x16x32_bf16 v[204:207], v[52:55], v[152:155], v[204:207]
    v_mfma_f32_16x16x32_bf16 v[212:215], v[52:55], v[180:183], v[212:215]
    s_waitcnt lgkmcnt(6)
    v_mfma_f32_16x16x32_bf16 v[200:203], v[56:59], v[156:159], v[200:203]
    v_mfma_f32_16x16x32_bf16 v[208:211], v[56:59], v[184:187], v[208:211]
    v_mfma_f32_16x16x32_bf16 v[204:207], v[60:63], v[156:159], v[204:207]
    v_mfma_f32_16x16x32_bf16 v[212:215], v[60:63], v[184:187], v[212:215]
    s_waitcnt lgkmcnt(4)
    v_mfma_f32_16x16x32_bf16 v[200:203], v[112:115], v[160:163], v[200:203]
    v_mfma_f32_16x16x32_bf16 v[208:211], v[112:115], v[188:191], v[208:211]
    v_mfma_f32_16x16x32_bf16 v[204:207], v[116:119], v[160:163], v[204:207]
    v_mfma_f32_16x16x32_bf16 v[212:215], v[116:119], v[188:191], v[212:215]
    s_waitcnt lgkmcnt(2)
    v_mfma_f32_16x16x32_bf16 v[200:203], v[24:27], v[164:167], v[200:203]
    v_mfma_f32_16x16x32_bf16 v[208:211], v[24:27], v[192:195], v[208:211]
    v_mfma_f32_16x16x32_bf16 v[204:207], v[28:31], v[164:167], v[204:207]
    v_mfma_f32_16x16x32_bf16 v[212:215], v[28:31], v[192:195], v[212:215]
    s_waitcnt lgkmcnt(0)
    v_mfma_f32_16x16x32_bf16 v[200:203], v[32:35], v[168:171], v[200:203]
    v_mfma_f32_16x16x32_bf16 v[208:211], v[32:35], v[196:199], v[208:211]
    v_mfma_f32_16x16x32_bf16 v[204:207], v[36:39], v[168:171], v[204:207]
    v_mfma_f32_16x16x32_bf16 v[212:215], v[36:39], v[196:199], v[212:215]
    s_branch L_p7join
L_p7b:
    s_waitcnt lgkmcnt(0)
    buffer_store_dwordx4 v[24:27], v141, s[44:47], s74 offen sc1
    s_add_u32 s74, s74, 1054720
    buffer_store_dwordx4 v[28:31], v141, s[44:47], s74 offen sc1
    s_cmp_eq_u32 s52, 1
    s_cbranch_scc0 sk_17
    s_load_dwordx16 s[20:35], s[18:19], s77 glc
sk_17:
    v_lshrrev_b32 v18, 3, v0
    v_lshl_add_u32 v18, s52, 3, v18
    v_mul_u32_u24 v12, 896, v18
    v_and_b32 v18, 4, v143
    v_xor_b32 v18, v18, v0
    v_and_b32 v18, 7, v18
    s_lshl_b32 s3, s54, 7
    v_lshl_add_u32 v12, v18, 4, v12
    v_add_u32 v12, s3, v12
    v_add_u32 v13, 28672, v12
    s_and_b32 s65, s53, 3
    s_mul_i32 s65, s65, 0
    s_cmp_eq_u32 s54, 7
    s_cselect_b32 s38, 0, s38
    s_add_u32 s66, s78, 40960
    v_and_b32 v16, 31, v0
    v_lshrrev_b32 v17, 5, v0
    v_bfe_u32 v18, v0, 1, 2
    v_xor_b32 v18, v18, v17
    s_lshl1_add_u32 s3, s78, 98304
    v_lshl_add_u32 v19, v16, 6, s3
    v_lshl_add_u32 v122, v18, 4, v19
    v_xor_b32 v123, 32, v122
    v_mul_u32_u24 v124, 1792, v143
    v_add_u32 v124, v124, v142
    v_add_u32 v125, 28672, v124
    s_lshl_b32 s3, s57, 12
    v_lshl_add_u32 v126, v16, 3, s3
    v_lshl_add_u32 v126, v17, 9, v126
    s_lshl1_add_u32 s3, s53, s57
    s_mul_i32 s3, s3, 57344
    s_lshl1_add_u32 s7, s54, s58
    s_lshl_b32 s7, s7, 6
    s_add_u32 s3, s3, s7
    s_add_u32 s10, s3, 896
    s_lshl_b32 s3, s58, 6
    s_add_u32 s3, s3, 40960
    v_bfe_u32 v18, v0, 4, 1
    v_lshl_add_u32 v18, v18, 5, s3
    v_and_b32 v19, 1, v0
    v_lshl_add_u32 v18, v19, 4, v18
    v_bfe_u32 v19, v0, 1, 1
    v_lshl_add_u32 v18, v19, 3, v18
    v_and_b32 v19, 8, v0
    v_lshlrev_b32 v19, 3, v19
    v_xor_b32 v18, v18, v19
    v_and_b32 v19, 44, v0
    v_lshl_add_u32 v120, v19, 5, v18
    s_cmp_eq_u32 s58, 1
    s_cselect_b64 vcc, -1, 0
    s_lshl_b32 s3, s57, 10
    s_add_u32 s3, s3, s53
    v_lshl_add_u32 v18, v143, 5, s3
    v_sub_u32 v19, 0, v18
    v_and_b32 v19, 2047, v19
    v_cndmask_b32 v19, v18, v19, vcc
    v_mul_u32_u24 v19, 1792, v19
    v_add_u32 v136, v19, v142
    v_add_u32 v18, 512, v18
    v_sub_u32 v19, 0, v18
    v_and_b32 v19, 2047, v19
    v_cndmask_b32 v19, v18, v19, vcc
    v_mul_u32_u24 v19, 1792, v19
    v_add_u32 v137, v19, v142
    s_lshl_b32 s3, s54, 6
    s_sub_u32 s7, 832, s3
    s_cmp_eq_u32 s58, 1
    s_cselect_b32 s64, s7, s3
    v_and_b32 v18, 19, v0
    v_bfe_u32 v19, v0, 2, 1
    v_lshl_add_u32 v18, v19, 3, v18
    v_bfe_u32 v19, v0, 3, 1
    v_lshl_add_u32 v18, v19, 2, v18
    v_sub_u32 v19, 32, v18
    v_cndmask_b32 v18, v18, v19, vcc
    v_lshrrev_b32 v19, 5, v18
    v_and_b32 v18, 31, v18
    v_lshlrev_b32 v18, 2, v18
    v_lshl_add_u32 v18, v19, 13, v18
    v_lshl_add_u32 v18, v17, 10, v18
    v_add_u32 v138, 147456, v18
    v_add_u32 v139, 128, v138
    s_waitcnt vmcnt(6)
    s_barrier
    s_waitcnt vmcnt(4)
    s_barrier
    s_cmp_eq_u32 s52, 1
    s_cbranch_scc0 sk_18
    s_mov_b32 s79, 16384
    s_mov_b32 s7, s6
kvp_19:
    s_waitcnt lgkmcnt(0)
    s_xor_b64 s[20:21], s[20:21], s[6:7]
    s_xor_b64 s[22:23], s[22:23], s[6:7]
    s_or_b64 s[20:21], s[20:21], s[22:23]
    s_xor_b64 s[24:25], s[24:25], s[6:7]
    s_or_b64 s[20:21], s[20:21], s[24:25]
    s_xor_b64 s[26:27], s[26:27], s[6:7]
    s_or_b64 s[20:21], s[20:21], s[26:27]
    s_xor_b64 s[28:29], s[28:29], s[6:7]
    s_or_b64 s[20:21], s[20:21], s[28:29]
    s_cbranch_scc0 kvp_19_d
    s_load_dwordx16 s[20:35], s[18:19], s77 glc
    s_sub_u32 s79, s79, 1
    s_cbranch_scc0 kvp_19
    s_waitcnt lgkmcnt(0)
kvp_19_d:
sk_18:
    s_waitcnt vmcnt(2)
    s_barrier
    s_add_u32 m0, s0, 135168
    s_mov_b32 exec_hi, 0x00ffffff
    buffer_load_dwordx4 v127, s[44:47], s8 offen offset:0 sc1 lds
    buffer_load_dwordx4 v127, s[44:47], s8 offen offset:896 sc1 lds
    s_mov_b32 exec_hi, -1
    s_add_u32 m0, s0, 128000
    s_mov_b32 exec_hi, 0x00ffffff
    buffer_load_dwordx4 v127, s[44:47], s15 offen offset:0 sc1 lds
    buffer_load_dwordx4 v127, s[44:47], s15 offen offset:896 sc1 lds
    s_mov_b32 exec_hi, -1
    s_add_u32 m0, s0, 120832
    s_mov_b32 exec_hi, 0x00ffffff
    buffer_load_dwordx4 v127, s[44:47], s14 offen offset:0 sc1 lds
    buffer_load_dwordx4 v127, s[44:47], s14 offen offset:896 sc1 lds
    s_mov_b32 exec_hi, -1
    s_barrier
    s_mov_b64 exec, 0xfffff
    ds_write_b128 v132, v[128:131] offset:896
    s_mov_b64 exec, -1
    s_branch L_p7join2
xm_15_n:
    s_sub_u32 s20, s20, s6
    s_sub_u32 s21, s21, s6
    s_max_u32 s20, s20, s21
    s_sub_u32 s22, s22, s6
    s_max_u32 s20, s20, s22
    s_sub_u32 s23, s23, s6
    s_max_u32 s20, s20, s23
    s_sub_u32 s24, s24, s6
    s_max_u32 s20, s20, s24
    s_sub_u32 s25, s25, s6
    s_max_u32 s20, s20, s25
    s_sub_u32 s26, s26, s6
    s_max_u32 s20, s20, s26
    s_sub_u32 s27, s27, s6
    s_max_u32 s20, s20, s27
    s_cmp_lt_u32 s20, 16
    s_cbranch_scc1 xm_15_s
    s_load_dwordx8 s[20:27], s[18:19], s76 glc
    s_sub_u32 s79, s79, 1
    s_cbranch_scc0 xm_15
xm_15_s:
    v_mov_b32 v21, 0
    s_branch xm_15_e
L_epoch:
    s_waitcnt lgkmcnt(0)
    s_barrier
    s_barrier
    s_barrier
    s_barrier
    s_cmp_lg_u32 s53, 31
    s_cbranch_scc1 L_g2end
    s_mov_b32 s79, 0
poll_801:
    buffer_load_dword v20, v18, s[44:47], s75 offen offset:0 sc1
    buffer_load_dword v21, v18, s[44:47], s75 offen offset:1024 sc1
    buffer_load_dword v22, v18, s[44:47], s75 offen offset:2048 sc1
    buffer_load_dword v23, v18, s[44:47], s75 offen offset:3072 sc1
    s_add_u32 s79, s79, 1
    s_cmp_gt_u32 s79, 16384
    s_cbranch_scc1 poll_801_d
    s_waitcnt vmcnt(0)
    v_cmp_ne_u32 vcc, s6, v20
    s_nop 0
    s_cbranch_vccnz poll_801
    v_cmp_ne_u32 vcc, s6, v21
    s_nop 0
    s_cbranch_vccnz poll_801
    v_cmp_ne_u32 vcc, s6, v22
    s_nop 0
    s_cbranch_vccnz poll_801
    v_cmp_ne_u32 vcc, s6, v23
    s_nop 0
    s_cbranch_vccnz poll_801
poll_801_d:
    s_atomic_swap s6, s[18:19], 0
    s_branch L_g2end
L_x7:
    v_mov_b32 v43, s72
    v_cndmask_b32 v45, v43, v42, vcc
    s_mul_i32 s74, s58, 48
    s_add_u32 s74, s74, 147456
    v_bfe_u32 v42, v0, 4, 1
    v_lshl_add_u32 v42, v42, 5, s74
    v_and_b32 v43, 1, v0
    v_lshl_add_u32 v42, v43, 4, v42
    v_bfe_u32 v43, v0, 1, 1
    v_lshl_add_u32 v42, v43, 3, v42
    v_and_b32 v43, 8, v0
    v_lshlrev_b32 v43, 3, v43
    v_xor_b32 v42, v42, v43
    v_and_b32 v43, 44, v0
    v_lshl_add_u32 v7, v43, 5, v42
    s_lshl_b32 s3, s53, 7
    v_lshl_add_u32 v17, v12, 2, s3
    v_lshlrev_b32 v42, 2, v20
    v_sub_u32 v21, v12, v42
    s_mov_b32 s11, 0x3e8b97f6
    s_mov_b32 s3, 0x0b0b0909
    v_subrev_u32 v42, 0, v21
    v_subrev_u32 v43, 1, v21
    v_perm_b32 v32, v43, v42, s3
    v_subrev_u32 v42, 2, v21
    v_subrev_u32 v43, 3, v21
    v_perm_b32 v33, v43, v42, s3
    v_subrev_u32 v42, 8, v21
    v_subrev_u32 v43, 9, v21
    v_perm_b32 v34, v43, v42, s3
    v_subrev_u32 v42, 10, v21
    v_subrev_u32 v43, 11, v21
    v_perm_b32 v35, v43, v42, s3
    v_subrev_u32 v42, 16, v21
    v_subrev_u32 v43, 17, v21
    v_perm_b32 v36, v43, v42, s3
    v_subrev_u32 v42, 18, v21
    v_subrev_u32 v43, 19, v21
    v_perm_b32 v37, v43, v42, s3
    v_subrev_u32 v42, 24, v21
    v_subrev_u32 v43, 25, v21
    v_perm_b32 v38, v43, v42, s3
    v_subrev_u32 v42, 26, v21
    v_subrev_u32 v43, 27, v21
    v_perm_b32 v39, v43, v42, s3
    s_mul_i32 s3, s57, 3584
    s_mul_i32 s7, s58, 1536
    s_add_u32 s3, s3, s7
    s_add_u32 s3, s3, 106496
    v_lshl_add_u32 v14, v0, 4, s3
    v_cmp_gt_u32 vcc, 28, v12
    s_mul_i32 s3, s58, 28
    v_add_u32 v42, s3, v12
    s_lshl_b32 s7, s58, 2
    s_sub_u32 s7, 60, s7
    v_mov_b32 v43, s7
    v_cndmask_b32 v42, v43, v42, vcc
    s_lshl_b32 s3, s57, 12
    v_lshl_add_u32 v42, v42, 4, s3
    v_lshl_add_u32 v15, v20, 10, v42
    v_cmp_gt_u32 vcc, s58, v20
    v_cmp_lt_u32 s[26:27], s58, v20
    v_lshlrev_b32 v42, 3, v12
    v_lshl_add_u32 v16, v20, 8, v42
    v_mov_b32 v42, 0x3e8b97f6
    v_cndmask_b32 v22, v42, v11, vcc
    v_cndmask_b32 v23, v42, v11, s[26:27]
    s_barrier
    ds_read_b128 v[144:147], v1 offset:0
    ds_read_b128 v[148:151], v2 offset:0
    ds_read_b128 v[152:155], v3 offset:0
    ds_read_b128 v[156:159], v4 offset:0
    ds_read_b128 v[160:163], v1 offset:16384
    ds_read_b128 v[164:167], v2 offset:16384
    ds_read_b128 v[168:171], v3 offset:16384
    ds_read_b128 v[172:175], v4 offset:16384
    ds_read_b128 v[176:179], v1 offset:32768
    ds_read_b128 v[180:183], v2 offset:32768
    ds_read_b128 v[184:187], v3 offset:32768
    ds_read_b128 v[188:191], v4 offset:32768
    ds_read_b128 v[192:195], v1 offset:49152
    ds_read_b128 v[196:199], v2 offset:49152
    ds_read_b128 v[200:203], v3 offset:49152
    ds_read_b128 v[204:207], v4 offset:49152
    v_add_u32 v1, 0x10000, v1
    ds_read_b128 v[208:211], v1 offset:0
    v_add_u32 v2, 0x10000, v2
    ds_read_b128 v[212:215], v2 offset:0
    v_add_u32 v3, 0x10000, v3
    ds_read_b128 v[216:219], v3 offset:0
    v_add_u32 v4, 0x10000, v4
    ds_read_b128 v[220:223], v4 offset:0
    ds_read_b128 v[224:227], v1 offset:16384
    ds_read_b128 v[228:231], v2 offset:16384
    ds_read_b128 v[232:235], v3 offset:16384
    ds_read_b128 v[236:239], v4 offset:16384
    ds_read_b128 v[240:243], v1 offset:32768
    ds_read_b128 v[244:247], v2 offset:32768
    ds_read_b128 v[248:251], v3 offset:32768
    ds_read_b128 v[252:255], v4 offset:32768
    s_barrier
    s_waitcnt lgkmcnt(0)
    s_branch L_s0
L_q7:
    s_waitcnt lgkmcnt(0)
    v_mfma_f32_32x32x16_bf16 v[80:95], v[112:115], v[240:243], v[80:95]
    v_mfma_f32_32x32x16_bf16 v[80:95], v[116:119], v[244:247], v[80:95]
    v_mfma_f32_32x32x16_bf16 v[80:95], v[120:123], v[248:251], v[80:95]
    v_mfma_f32_32x32x16_bf16 v[80:95], v[124:127], v[252:255], v[80:95]
    s_barrier
    s_nop 10
    v_mul_f32 v80, v22, v80
    v_mul_f32 v81, v22, v81
    v_cvt_pk_bf16_f32 v24, v80, v81
    v_mul_f32 v82, v22, v82
    v_mul_f32 v83, v22, v83
    v_cvt_pk_bf16_f32 v25, v82, v83
    v_mul_f32 v84, s11, v84
    v_mul_f32 v85, s11, v85
    v_cvt_pk_bf16_f32 v26, v84, v85
    v_mul_f32 v86, s11, v86
    v_mul_f32 v87, s11, v87
    v_cvt_pk_bf16_f32 v27, v86, v87
    v_mul_f32 v88, s11, v88
    v_mul_f32 v89, s11, v89
    v_cvt_pk_bf16_f32 v28, v88, v89
    v_mul_f32 v90, s11, v90
    v_mul_f32 v91, s11, v91
    v_cvt_pk_bf16_f32 v29, v90, v91
    v_mul_f32 v92, v23, v92
    v_mul_f32 v93, v23, v93
    v_cvt_pk_bf16_f32 v30, v92, v93
    v_mul_f32 v94, v23, v94
    v_mul_f32 v95, v23, v95
    v_cvt_pk_bf16_f32 v31, v94, v95
    s_branch L_vdone
L_oslow:
    v_pk_mul_f32 v[96:97], v[40:41], v[80:81] op_sel:[1,0]
    v_pk_mul_f32 v[98:99], v[40:41], v[82:83] op_sel:[1,0]
    v_cvt_pk_bf16_f32 v128, v96, v97
    v_cvt_pk_bf16_f32 v129, v98, v99
    buffer_store_dwordx2 v[128:129], v16, s[44:47], s73 offen offset:0 sc1
    v_pk_mul_f32 v[100:101], v[40:41], v[84:85] op_sel:[1,0]
    v_pk_mul_f32 v[102:103], v[40:41], v[86:87] op_sel:[1,0]
    v_cvt_pk_bf16_f32 v130, v100, v101
    v_cvt_pk_bf16_f32 v131, v102, v103
    buffer_store_dwordx2 v[130:131], v16, s[44:47], s73 offen offset:512 sc1
    v_pk_mul_f32 v[104:105], v[40:41], v[88:89] op_sel:[1,0]
    v_pk_mul_f32 v[106:107], v[40:41], v[90:91] op_sel:[1,0]
    v_cvt_pk_bf16_f32 v132, v104, v105
    v_cvt_pk_bf16_f32 v133, v106, v107
    buffer_store_dwordx2 v[132:133], v16, s[44:47], s73 offen offset:1024 sc1
    v_pk_mul_f32 v[108:109], v[40:41], v[92:93] op_sel:[1,0]
    v_pk_mul_f32 v[110:111], v[40:41], v[94:95] op_sel:[1,0]
    v_cvt_pk_bf16_f32 v134, v108, v109
    v_cvt_pk_bf16_f32 v135, v110, v111
    s_mov_b32 exec_hi, 0
    buffer_store_dwordx2 v[134:135], v16, s[44:47], s73 offen offset:1536 sc1
    s_mov_b64 exec, -1
    s_branch L_ostored
L_ofslow:
    buffer_store_dword v18, v11, s[44:47], s72 offen sc1
    s_branch L_oflagged
    .p2alignl 12, 0xbf810000
    .fill 342, 4, 0xbf810000
L_g1:
    s_waitcnt lgkmcnt(0)
    s_load_dword s6, s[18:19], 0
    s_mov_b64 s[44:45], s[18:19]
    s_mov_b32 s46, 0xb00000
    s_mov_b32 s47, 0x20000
    s_mov_b64 s[36:37], s[12:13]
    s_mov_b32 s38, 0x62000
    s_mov_b32 s39, 0x20000
    s_mov_b32 s34, 0x1c0000
    s_mov_b32 s35, 0x20000
    s_lshl2_add_u32 s10, s2, s52
    s_mulk_i32 s10, 392
    v_lshlrev_b32 v40, 3, v0
    buffer_load_dword v47, v40, s[36:39], s10 offen
    s_cmp_lg_u32 s54, 7
    s_cbranch_scc1 pf_20
    s_and_b32 s7, s53, 3
    s_lshl2_add_u32 s7, s7, s52
    s_mul_i32 s10, s7, 114688
    s_mul_i32 s11, s3, 7168
    s_add_u32 s10, s10, s11
    v_lshlrev_b32 v40, 7, v0
    s_mov_b32 exec_hi, 0x00ffffff
    buffer_load_dword v47, v40, s[32:35], s10 offen
    s_add_u32 s10, s10, 57344
    buffer_load_dword v47, v40, s[32:35], s10 offen
    s_add_u32 s10, s10, 57344
    s_mov_b64 exec, -1
pf_20:
    v_and_b32 v12, 31, v0
    v_lshrrev_b32 v20, 5, v0
    v_bfe_u32 v42, v0, 1, 3
    v_xor_b32 v42, v42, v20
    s_lshl_b32 s3, s57, 12
    v_lshl_add_u32 v43, v12, 7, s3
    v_lshl_add_u32 v1, v42, 4, v43
    v_xor_b32 v2, 32, v1
    v_xor_b32 v3, 64, v1
    v_xor_b32 v4, 96, v1
    s_lshl_b32 s74, s58, 6
    v_bfe_u32 v42, v0, 4, 1
    v_lshl_add_u32 v42, v42, 5, s74
    v_and_b32 v43, 1, v0
    v_lshl_add_u32 v42, v43, 4, v42
    v_bfe_u32 v43, v0, 1, 1
    v_lshl_add_u32 v42, v43, 3, v42
    v_and_b32 v43, 8, v0
    v_lshlrev_b32 v43, 3, v43
    v_xor_b32 v42, v42, v43
    v_and_b32 v43, 44, v0
    v_lshl_add_u32 v5, v43, 5, v42
    s_add_u32 s74, s74, 40960
    v_bfe_u32 v42, v0, 4, 1
    v_lshl_add_u32 v42, v42, 5, s74
    v_and_b32 v43, 3, v0
    v_lshl_add_u32 v42, v43, 3, v42
    v_and_b32 v43, 8, v0
    v_lshlrev_b32 v43, 3, v43
    v_xor_b32 v42, v42, v43
    v_and_b32 v43, 44, v0
    v_lshl_add_u32 v6, v43, 5, v42
    s_lshl1_add_u32 s67, s53, s57
    s_lshl1_add_u32 s3, s54, s58
    s_mov_b32 s7, 225792
    v_lshl_add_u32 v42, s3, 2, v20
    v_mul_u32_u24 v43, 37, v42
    v_lshrrev_b32 v43, 8, v43
    v_mul_lo_u32 v43, v43, s7
    v_lshl_add_u32 v43, v42, 9, v43
    v_lshl_add_u32 v8, v12, 4, v43
    v_add_u32 v42, 2, v42
    v_mul_u32_u24 v43, 37, v42
    v_lshrrev_b32 v43, 8, v43
    v_mul_lo_u32 v43, v43, s7
    v_lshl_add_u32 v43, v42, 9, v43
    v_lshl_add_u32 v9, v12, 4, v43
    s_mul_i32 s3, s67, 3584
    s_add_u32 s68, s3, 0x201000
    s_add_u32 s69, s3, 0x401000
    v_mov_b32 v11, 0
    v_mov_b32 v19, 147392
    s_lshl1_add_u32 s3, s54, s58
    v_lshl_add_u32 v42, s3, 5, v12
    v_mul_u32_u24 v43, 1171, v42
    v_lshrrev_b32 v43, 16, v43
    s_mov_b32 s7, 228480
    v_mul_lo_u32 v43, v43, s7
    v_lshl_add_u32 v43, v42, 4, v43
    v_mul_u32_u24 v42, 896, v20
    v_add_u32 v10, v42, v43
    s_mul_i32 s3, s3, 1792
    s_mul_i32 s7, s67, 28672
    s_add_u32 s3, s3, s7
    s_add_u32 s73, s3, 0x601000
    s_lshl3_add_u32 s3, s53, s54
    s_lshl2_add_u32 s3, s3, s52
    s_lshl_b32 s3, s3, 2
    s_add_u32 s72, s3, 0x20000
    s_mov_b32 s71, 0
    v_cmp_gt_u32 vcc, 14, v0
    v_lshl_add_u32 v42, v0, 7, s73
    s_cmp_eq_u32 s54, 7
    s_cbranch_scc1 L_x7
    s_setprio 1
    s_barrier
    ds_read_b128 v[144:147], v1 offset:0
    ds_read_b64_tr_b16 v[112:113], v5 offset:8192
    ds_read_b64_tr_b16 v[114:115], v5 offset:8704
    ds_read_b128 v[148:151], v2 offset:0
    ds_read_b64_tr_b16 v[116:117], v5 offset:10240
    ds_read_b64_tr_b16 v[118:119], v5 offset:10752
    ds_read_b128 v[152:155], v3 offset:0
    ds_read_b64_tr_b16 v[120:121], v5 offset:12288
    ds_read_b64_tr_b16 v[122:123], v5 offset:12800
    ds_read_b128 v[156:159], v4 offset:0
    ds_read_b64_tr_b16 v[124:125], v5 offset:14336
    ds_read_b64_tr_b16 v[126:127], v5 offset:14848
    v_mov_b32 v43, s72
    v_cndmask_b32 v45, v43, v42, vcc
    s_mul_i32 s74, s58, 48
    s_add_u32 s74, s74, 147456
    v_bfe_u32 v42, v0, 4, 1
    v_lshl_add_u32 v42, v42, 5, s74
    v_and_b32 v43, 1, v0
    v_lshl_add_u32 v42, v43, 4, v42
    v_bfe_u32 v43, v0, 1, 1
    v_lshl_add_u32 v42, v43, 3, v42
    v_and_b32 v43, 8, v0
    v_lshlrev_b32 v43, 3, v43
    v_xor_b32 v42, v42, v43
    v_and_b32 v43, 44, v0
    v_lshl_add_u32 v7, v43, 5, v42
    s_lshl_b32 s3, s53, 7
    s_barrier
    s_waitcnt lgkmcnt(9)
    v_mfma_f32_32x32x16_bf16 v[48:63], v[112:115], v[144:147], 0
    ds_read_b128 v[160:163], v1 offset:16384
    ds_read_b64_tr_b16 v[128:129], v5 offset:24576
    ds_read_b64_tr_b16 v[130:131], v5 offset:25088
    s_waitcnt lgkmcnt(9)
    v_mfma_f32_32x32x16_bf16 v[48:63], v[116:119], v[148:151], v[48:63]
    ds_read_b128 v[164:167], v2 offset:16384
    ds_read_b64_tr_b16 v[132:133], v5 offset:26624
    ds_read_b64_tr_b16 v[134:135], v5 offset:27136
    s_waitcnt lgkmcnt(9)
    v_mfma_f32_32x32x16_bf16 v[48:63], v[120:123], v[152:155], v[48:63]
    ds_read_b128 v[168:171], v3 offset:16384
    ds_read_b64_tr_b16 v[136:137], v5 offset:28672
    ds_read_b64_tr_b16 v[138:139], v5 offset:29184
    s_waitcnt lgkmcnt(9)
    v_mfma_f32_32x32x16_bf16 v[48:63], v[124:127], v[156:159], v[48:63]
    ds_read_b128 v[172:175], v4 offset:16384
    ds_read_b64_tr_b16 v[140:141], v5 offset:30720
    ds_read_b64_tr_b16 v[142:143], v5 offset:31232
    v_lshl_add_u32 v17, v12, 2, s3
    v_lshlrev_b32 v42, 2, v20
    v_sub_u32 v21, v12, v42
    s_mov_b32 s11, 0x3e8b97f6
    s_mov_b32 s3, 0x0b0b0909
    v_subrev_u32 v42, 0, v21
    v_subrev_u32 v43, 1, v21
    v_perm_b32 v32, v43, v42, s3
    v_subrev_u32 v42, 2, v21
    v_subrev_u32 v43, 3, v21
    v_perm_b32 v33, v43, v42, s3
    v_subrev_u32 v42, 8, v21
    v_subrev_u32 v43, 9, v21
    v_perm_b32 v34, v43, v42, s3
    v_subrev_u32 v42, 10, v21
    v_subrev_u32 v43, 11, v21
    s_barrier
    s_waitcnt lgkmcnt(9)
    v_mfma_f32_32x32x16_bf16 v[48:63], v[128:131], v[160:163], v[48:63]
    ds_read_b128 v[176:179], v1 offset:32768
    ds_read_b64_tr_b16 v[112:113], v5 offset:40960
    ds_read_b64_tr_b16 v[114:115], v5 offset:41472
    s_waitcnt lgkmcnt(9)
    v_mfma_f32_32x32x16_bf16 v[48:63], v[132:135], v[164:167], v[48:63]
    ds_read_b128 v[180:183], v2 offset:32768
    ds_read_b64_tr_b16 v[116:117], v5 offset:43008
    ds_read_b64_tr_b16 v[118:119], v5 offset:43520
    s_waitcnt lgkmcnt(9)
    v_mfma_f32_32x32x16_bf16 v[48:63], v[136:139], v[168:171], v[48:63]
    ds_read_b128 v[184:187], v3 offset:32768
    ds_read_b64_tr_b16 v[120:121], v5 offset:45056
    ds_read_b64_tr_b16 v[122:123], v5 offset:45568
    s_waitcnt lgkmcnt(9)
    v_mfma_f32_32x32x16_bf16 v[48:63], v[140:143], v[172:175], v[48:63]
    ds_read_b128 v[188:191], v4 offset:32768
    ds_read_b64_tr_b16 v[124:125], v5 offset:47104
    ds_read_b64_tr_b16 v[126:127], v5 offset:47616
    v_perm_b32 v35, v43, v42, s3
    v_subrev_u32 v42, 16, v21
    v_subrev_u32 v43, 17, v21
    v_perm_b32 v36, v43, v42, s3
    v_subrev_u32 v42, 18, v21
    v_subrev_u32 v43, 19, v21
    v_perm_b32 v37, v43, v42, s3
    v_subrev_u32 v42, 24, v21
    v_subrev_u32 v43, 25, v21
    v_perm_b32 v38, v43, v42, s3
    v_subrev_u32 v42, 26, v21
    v_subrev_u32 v43, 27, v21
    v_perm_b32 v39, v43, v42, s3
    s_mul_i32 s3, s57, 3584
    s_mul_i32 s7, s58, 1536
    s_add_u32 s3, s3, s7
    s_barrier
    s_waitcnt lgkmcnt(9)
    v_mfma_f32_32x32x16_bf16 v[48:63], v[112:115], v[176:179], v[48:63]
    ds_read_b128 v[192:195], v1 offset:49152
    ds_read_b64_tr_b16 v[128:129], v5 offset:57344
    ds_read_b64_tr_b16 v[130:131], v5 offset:57856
    s_waitcnt lgkmcnt(9)
    v_mfma_f32_32x32x16_bf16 v[48:63], v[116:119], v[180:183], v[48:63]
    ds_read_b128 v[196:199], v2 offset:49152
    ds_read_b64_tr_b16 v[132:133], v5 offset:59392
    ds_read_b64_tr_b16 v[134:135], v5 offset:59904
    s_waitcnt lgkmcnt(9)
    v_mfma_f32_32x32x16_bf16 v[48:63], v[120:123], v[184:187], v[48:63]
    ds_read_b128 v[200:203], v3 offset:49152
    ds_read_b64_tr_b16 v[136:137], v5 offset:61440
    ds_read_b64_tr_b16 v[138:139], v5 offset:61952
    s_waitcnt lgkmcnt(9)
    v_mfma_f32_32x32x16_bf16 v[48:63], v[124:127], v[188:191], v[48:63]
    ds_read_b128 v[204:207], v4 offset:49152
    ds_read_b64_tr_b16 v[140:141], v5 offset:63488
    ds_read_b64_tr_b16 v[142:143], v5 offset:64000
    s_add_u32 s3, s3, 106496
    v_lshl_add_u32 v14, v0, 4, s3
    v_cmp_gt_u32 vcc, 28, v12
    s_mul_i32 s3, s58, 28
    v_add_u32 v42, s3, v12
    s_lshl_b32 s7, s58, 2
    s_sub_u32 s7, 60, s7
    v_mov_b32 v43, s7
    v_cndmask_b32 v42, v43, v42, vcc
    s_lshl_b32 s3, s57, 12
    v_lshl_add_u32 v42, v42, 4, s3
    v_lshl_add_u32 v15, v20, 10, v42
    v_cmp_gt_u32 vcc, s58, v20
    v_cmp_lt_u32 s[26:27], s58, v20
    v_lshlrev_b32 v42, 3, v12
    v_lshl_add_u32 v16, v20, 8, v42
    s_barrier
    s_waitcnt lgkmcnt(9)
    v_mfma_f32_32x32x16_bf16 v[48:63], v[128:131], v[192:195], v[48:63]
    v_add_u32 v1, 0x10000, v1
    ds_read_b128 v[208:211], v1 offset:0
    v_add_u32 v5, 0x12000, v5
    ds_read_b64_tr_b16 v[112:113], v5 offset:0
    ds_read_b64_tr_b16 v[114:115], v5 offset:512
    s_waitcnt lgkmcnt(9)
    v_mfma_f32_32x32x16_bf16 v[48:63], v[132:135], v[196:199], v[48:63]
    v_add_u32 v2, 0x10000, v2
    ds_read_b128 v[212:215], v2 offset:0
    ds_read_b64_tr_b16 v[116:117], v5 offset:2048
    ds_read_b64_tr_b16 v[118:119], v5 offset:2560
    s_waitcnt lgkmcnt(9)
    v_mfma_f32_32x32x16_bf16 v[48:63], v[136:139], v[200:203], v[48:63]
    v_add_u32 v3, 0x10000, v3
    ds_read_b128 v[216:219], v3 offset:0
    ds_read_b64_tr_b16 v[120:121], v5 offset:4096
    ds_read_b64_tr_b16 v[122:123], v5 offset:4608
    s_waitcnt lgkmcnt(9)
    v_mfma_f32_32x32x16_bf16 v[48:63], v[140:143], v[204:207], v[48:63]
    v_add_u32 v4, 0x10000, v4
    ds_read_b128 v[220:223], v4 offset:0
    ds_read_b64_tr_b16 v[124:125], v5 offset:6144
    ds_read_b64_tr_b16 v[126:127], v5 offset:6656
    s_waitcnt lgkmcnt(9)
    v_mfma_f32_32x32x16_bf16 v[48:63], v[112:115], v[208:211], v[48:63]
    s_waitcnt lgkmcnt(6)
    v_mfma_f32_32x32x16_bf16 v[48:63], v[116:119], v[212:215], v[48:63]
    v_mov_b32 v42, 0x3e8b97f6
    v_cndmask_b32 v22, v42, v11, vcc
    v_cndmask_b32 v23, v42, v11, s[26:27]
    s_barrier
    s_waitcnt lgkmcnt(3)
    v_mfma_f32_32x32x16_bf16 v[48:63], v[120:123], v[216:219], v[48:63]
    ds_read_b128 v[224:227], v1 offset:16384
    ds_read_b64_tr_b16 v[128:129], v5 offset:16384
    ds_read_b64_tr_b16 v[130:131], v5 offset:16896
    s_waitcnt lgkmcnt(3)
    v_mfma_f32_32x32x16_bf16 v[48:63], v[124:127], v[220:223], v[48:63]
    ds_read_b128 v[228:231], v2 offset:16384
    ds_read_b64_tr_b16 v[132:133], v5 offset:18432
    ds_read_b64_tr_b16 v[134:135], v5 offset:18944
    ds_read_b128 v[232:235], v3 offset:16384
    ds_read_b64_tr_b16 v[136:137], v5 offset:20480
    ds_read_b64_tr_b16 v[138:139], v5 offset:20992
    ds_read_b128 v[236:239], v4 offset:16384
    ds_read_b64_tr_b16 v[140:141], v5 offset:22528
    ds_read_b64_tr_b16 v[142:143], v5 offset:23040
    s_waitcnt lgkmcnt(9)
    v_mfma_f32_32x32x16_bf16 v[48:63], v[128:131], v[224:227], v[48:63]
    s_waitcnt lgkmcnt(6)
    v_mfma_f32_32x32x16_bf16 v[48:63], v[132:135], v[228:231], v[48:63]
    s_waitcnt lgkmcnt(3)
    v_mfma_f32_32x32x16_bf16 v[48:63], v[136:139], v[232:235], v[48:63]
    s_waitcnt lgkmcnt(0)
    v_mfma_f32_32x32x16_bf16 v[48:63], v[140:143], v[236:239], v[48:63]
    s_barrier
    ds_read_b128 v[240:243], v1 offset:32768
    ds_read_b64_tr_b16 v[112:113], v5 offset:32768
    ds_read_b64_tr_b16 v[114:115], v5 offset:33280
    ds_read_b128 v[244:247], v2 offset:32768
    ds_read_b64_tr_b16 v[116:117], v5 offset:34816
    ds_read_b64_tr_b16 v[118:119], v5 offset:35328
    ds_read_b128 v[248:251], v3 offset:32768
    ds_read_b64_tr_b16 v[120:121], v5 offset:36864
    ds_read_b64_tr_b16 v[122:123], v5 offset:37376
    ds_read_b128 v[252:255], v4 offset:32768
    ds_read_b64_tr_b16 v[124:125], v5 offset:38912
    ds_read_b64_tr_b16 v[126:127], v5 offset:39424
    s_waitcnt lgkmcnt(9)
    v_mfma_f32_32x32x16_bf16 v[48:63], v[112:115], v[240:243], v[48:63]
    s_waitcnt lgkmcnt(6)
    v_mfma_f32_32x32x16_bf16 v[48:63], v[116:119], v[244:247], v[48:63]
    s_waitcnt lgkmcnt(3)
    v_mfma_f32_32x32x16_bf16 v[48:63], v[120:123], v[248:251], v[48:63]
    s_waitcnt lgkmcnt(0)
    v_mfma_f32_32x32x16_bf16 v[48:63], v[124:127], v[252:255], v[48:63]
    s_nop 11
    v_cvt_pk_bf16_f32 v24, v48, v49
    v_cvt_pk_bf16_f32 v25, v50, v51
    v_cvt_pk_bf16_f32 v26, v52, v53
    v_cvt_pk_bf16_f32 v27, v54, v55
    buffer_store_dwordx4 v[24:27], v8, s[44:47], s68 offen sc1
    v_cvt_pk_bf16_f32 v28, v56, v57
    v_cvt_pk_bf16_f32 v29, v58, v59
    v_cvt_pk_bf16_f32 v30, v60, v61
    v_cvt_pk_bf16_f32 v31, v62, v63
    buffer_store_dwordx4 v[28:31], v9, s[44:47], s68 offen sc1
L_s0:
    s_barrier
    s_setprio 0
    buffer_load_dword v47, v45, s[44:47], 0 offen sc1
    v_lshl_add_u32 v3, v12, 5, s53
    v_cvt_f32_u32 v3, v3
    v_mul_f32 v1, 0x3a000000, v3
    v_lshl_add_u32 v3, s52, 1, v20
    v_lshlrev_b32 v3, 3, v3
    v_cvt_f32_u32 v3, v3
    v_mul_f32 v2, v1, v3
    v_fmamk_f32 v84, v1, 0x0, v2
    v_fmamk_f32 v85, v1, 0x40000000, v2
    v_fmamk_f32 v86, v1, 0x40800000, v2
    v_fmamk_f32 v87, v1, 0x40c00000, v2
    v_cos_f32 v80, v84
    v_cos_f32 v81, v85
    v_cos_f32 v82, v86
    v_cos_f32 v83, v87
    v_sin_f32 v84, v84
    v_sin_f32 v85, v85
    v_sin_f32 v86, v86
    v_sin_f32 v87, v87
    v_cvt_pk_bf16_f32 v88, v80, -v84
    v_cvt_pk_bf16_f32 v89, v81, -v85
    v_cvt_pk_bf16_f32 v90, v82, -v86
    v_cvt_pk_bf16_f32 v91, v83, -v87
    v_fmamk_f32 v84, v1, 0x3f800000, v2
    v_fmamk_f32 v85, v1, 0x40400000, v2
    v_fmamk_f32 v86, v1, 0x40a00000, v2
    v_fmamk_f32 v87, v1, 0x40e00000, v2
    v_cos_f32 v80, v84
    v_cos_f32 v81, v85
    v_cos_f32 v82, v86
    v_cos_f32 v83, v87
    v_sin_f32 v84, v84
    v_sin_f32 v85, v85
    v_sin_f32 v86, v86
    v_sin_f32 v87, v87
    v_cvt_pk_bf16_f32 v92, v80, -v84
    v_cvt_pk_bf16_f32 v93, v81, -v85
    v_cvt_pk_bf16_f32 v94, v82, -v86
    v_cvt_pk_bf16_f32 v95, v83, -v87
    s_add_u32 s3, s78, 98304
    v_lshl_add_u32 v46, v0, 4, s3
    ds_write_b128 v46, v[88:91]
    ds_write_b128 v46, v[92:95] offset:4096
    v_lshrrev_b32 v42, 2, v12
    v_cmp_ne_u32 s[62:63], s54, v42
    s_mul_i32 s6, s6, 0x9E3779C1
    s_add_u32 s6, s6, 0x7FEB3560
    v_mov_b32 v18, s6
    v_cvt_f32_i32 v42, v21
    v_mul_f32 v42, 0x71800000, v42
    v_add_f32 v48, 0x0, v42
    v_add_f32 v49, 0xf1800000, v42
    v_add_f32 v50, 0xf2000000, v42
    v_add_f32 v51, 0xf2400000, v42
    v_add_f32 v52, 0xf3000000, v42
    v_add_f32 v53, 0xf3100000, v42
    v_add_f32 v54, 0xf3200000, v42
    v_add_f32 v55, 0xf3300000, v42
    v_add_f32 v56, 0xf3800000, v42
    v_add_f32 v57, 0xf3880000, v42
    v_add_f32 v58, 0xf3900000, v42
    v_add_f32 v59, 0xf3980000, v42
    v_add_f32 v60, 0xf3c00000, v42
    v_add_f32 v61, 0xf3c80000, v42
    v_add_f32 v62, 0xf3d00000, v42
    v_add_f32 v63, 0xf3d80000, v42
    v_min_f32 v48, 0, v48
    v_min_f32 v49, 0, v49
    v_min_f32 v50, 0, v50
    v_min_f32 v51, 0, v51
    v_min_f32 v52, 0, v52
    v_min_f32 v53, 0, v53
    v_min_f32 v54, 0, v54
    v_min_f32 v55, 0, v55
    v_min_f32 v56, 0, v56
    v_min_f32 v57, 0, v57
    v_min_f32 v58, 0, v58
    v_min_f32 v59, 0, v59
    v_min_f32 v60, 0, v60
    v_min_f32 v61, 0, v61
    v_min_f32 v62, 0, v62
    v_min_f32 v63, 0, v63
    s_mov_b32 s74, 0x20000
    s_lshl1_add_u32 s3, s53, s58
    s_mul_i32 s75, s3, 28672
    s_lshl_b32 s3, s57, 11
    s_add_u32 s75, s75, s3
    s_add_u32 s75, s75, 0x601000
    s_lshl_b32 s76, s78, 1
    v_lshlrev_b32 v13, 4, v0
    s_waitcnt lgkmcnt(0)
    s_setprio 1
L_g1page:
    s_branch L_over_g1p1
L_pad_g1p1:
    s_branch L_hopret
L_over_g1p1:
    s_waitcnt vmcnt(0)
    s_barrier
    ds_read_b64_tr_b16 v[112:113], v7 offset:0
    ds_read_b64_tr_b16 v[114:115], v7 offset:512
    ds_read_b64_tr_b16 v[116:117], v7 offset:2048
    ds_read_b64_tr_b16 v[118:119], v7 offset:2560
    ds_read_b64_tr_b16 v[120:121], v7 offset:4096
    ds_read_b64_tr_b16 v[122:123], v7 offset:4608
    ds_read_b64_tr_b16 v[124:125], v7 offset:6144
    ds_read_b64_tr_b16 v[126:127], v7 offset:6656
    s_waitcnt lgkmcnt(6)
    v_mfma_f32_32x32x16_bf16 v[80:95], v[112:115], v[144:147], 0
    ds_read_b64_tr_b16 v[128:129], v7 offset:8192
    ds_read_b64_tr_b16 v[130:131], v7 offset:8704
    s_waitcnt lgkmcnt(6)
    v_mfma_f32_32x32x16_bf16 v[80:95], v[116:119], v[148:151], v[80:95]
    ds_read_b64_tr_b16 v[132:133], v7 offset:10240
    ds_read_b64_tr_b16 v[134:135], v7 offset:10752
    s_waitcnt lgkmcnt(6)
    v_mfma_f32_32x32x16_bf16 v[80:95], v[120:123], v[152:155], v[80:95]
    ds_read_b64_tr_b16 v[136:137], v7 offset:12288
    ds_read_b64_tr_b16 v[138:139], v7 offset:12800
    s_waitcnt lgkmcnt(6)
    v_mfma_f32_32x32x16_bf16 v[80:95], v[124:127], v[156:159], v[80:95]
    ds_read_b64_tr_b16 v[140:141], v7 offset:14336
    ds_read_b64_tr_b16 v[142:143], v7 offset:14848
    s_waitcnt lgkmcnt(6)
    v_mfma_f32_32x32x16_bf16 v[80:95], v[128:131], v[160:163], v[80:95]
    v_add_u32 v7, 0xfffdc000, v7
    ds_read_b64_tr_b16 v[112:113], v7 offset:0
    ds_read_b64_tr_b16 v[114:115], v7 offset:512
    s_waitcnt lgkmcnt(6)
    v_mfma_f32_32x32x16_bf16 v[80:95], v[132:135], v[164:167], v[80:95]
    ds_read_b64_tr_b16 v[116:117], v7 offset:2048
    ds_read_b64_tr_b16 v[118:119], v7 offset:2560
    s_waitcnt lgkmcnt(6)
    v_mfma_f32_32x32x16_bf16 v[80:95], v[136:139], v[168:171], v[80:95]
    ds_read_b64_tr_b16 v[120:121], v7 offset:4096
    ds_read_b64_tr_b16 v[122:123], v7 offset:4608
    s_waitcnt lgkmcnt(6)
    v_mfma_f32_32x32x16_bf16 v[80:95], v[140:143], v[172:175], v[80:95]
    ds_read_b64_tr_b16 v[124:125], v7 offset:6144
    ds_read_b64_tr_b16 v[126:127], v7 offset:6656
    s_barrier
    s_waitcnt lgkmcnt(6)
    v_mfma_f32_32x32x16_bf16 v[80:95], v[112:115], v[176:179], v[80:95]
    ds_read_b64_tr_b16 v[128:129], v7 offset:8192
    ds_read_b64_tr_b16 v[130:131], v7 offset:8704
    s_waitcnt lgkmcnt(6)
    v_mfma_f32_32x32x16_bf16 v[80:95], v[116:119], v[180:183], v[80:95]
    ds_read_b64_tr_b16 v[132:133], v7 offset:10240
    ds_read_b64_tr_b16 v[134:135], v7 offset:10752
    s_waitcnt lgkmcnt(6)
    v_mfma_f32_32x32x16_bf16 v[80:95], v[120:123], v[184:187], v[80:95]
    ds_read_b64_tr_b16 v[136:137], v7 offset:12288
    ds_read_b64_tr_b16 v[138:139], v7 offset:12800
    s_waitcnt lgkmcnt(6)
    v_mfma_f32_32x32x16_bf16 v[80:95], v[124:127], v[188:191], v[80:95]
    ds_read_b64_tr_b16 v[140:141], v7 offset:14336
    ds_read_b64_tr_b16 v[142:143], v7 offset:14848
    s_waitcnt lgkmcnt(6)
    v_mfma_f32_32x32x16_bf16 v[80:95], v[128:131], v[192:195], v[80:95]
    ds_read_b64_tr_b16 v[112:113], v7 offset:16384
    ds_read_b64_tr_b16 v[114:115], v7 offset:16896
    s_waitcnt lgkmcnt(6)
    v_mfma_f32_32x32x16_bf16 v[80:95], v[132:135], v[196:199], v[80:95]
    ds_read_b64_tr_b16 v[116:117], v7 offset:18432
    ds_read_b64_tr_b16 v[118:119], v7 offset:18944
    s_waitcnt lgkmcnt(6)
    v_mfma_f32_32x32x16_bf16 v[80:95], v[136:139], v[200:203], v[80:95]
    ds_read_b64_tr_b16 v[120:121], v7 offset:20480
    ds_read_b64_tr_b16 v[122:123], v7 offset:20992
    s_waitcnt lgkmcnt(6)
    v_mfma_f32_32x32x16_bf16 v[80:95], v[140:143], v[204:207], v[80:95]
    ds_read_b64_tr_b16 v[124:125], v7 offset:22528
    ds_read_b64_tr_b16 v[126:127], v7 offset:23040
    s_barrier
    s_waitcnt lgkmcnt(6)
    v_mfma_f32_32x32x16_bf16 v[80:95], v[112:115], v[208:211], v[80:95]
    ds_read_b64_tr_b16 v[128:129], v7 offset:24576
    ds_read_b64_tr_b16 v[130:131], v7 offset:25088
    s_waitcnt lgkmcnt(6)
    v_mfma_f32_32x32x16_bf16 v[80:95], v[116:119], v[212:215], v[80:95]
    ds_read_b64_tr_b16 v[132:133], v7 offset:26624
    ds_read_b64_tr_b16 v[134:135], v7 offset:27136
    s_waitcnt lgkmcnt(6)
    v_mfma_f32_32x32x16_bf16 v[80:95], v[120:123], v[216:219], v[80:95]
    ds_read_b64_tr_b16 v[136:137], v7 offset:28672
    ds_read_b64_tr_b16 v[138:139], v7 offset:29184
    s_waitcnt lgkmcnt(6)
    v_mfma_f32_32x32x16_bf16 v[80:95], v[124:127], v[220:223], v[80:95]
    ds_read_b64_tr_b16 v[140:141], v7 offset:30720
    ds_read_b64_tr_b16 v[142:143], v7 offset:31232
    s_barrier
    s_waitcnt lgkmcnt(6)
    v_mfma_f32_32x32x16_bf16 v[80:95], v[128:131], v[224:227], v[80:95]
    ds_read_b64_tr_b16 v[112:113], v7 offset:32768
    ds_read_b64_tr_b16 v[114:115], v7 offset:33280
    s_waitcnt lgkmcnt(6)
    v_mfma_f32_32x32x16_bf16 v[80:95], v[132:135], v[228:231], v[80:95]
    ds_read_b64_tr_b16 v[116:117], v7 offset:34816
    ds_read_b64_tr_b16 v[118:119], v7 offset:35328
    s_waitcnt lgkmcnt(6)
    v_mfma_f32_32x32x16_bf16 v[80:95], v[136:139], v[232:235], v[80:95]
    ds_read_b64_tr_b16 v[120:121], v7 offset:36864
    ds_read_b64_tr_b16 v[122:123], v7 offset:37376
    s_waitcnt lgkmcnt(6)
    v_mfma_f32_32x32x16_bf16 v[80:95], v[140:143], v[236:239], v[80:95]
    ds_read_b64_tr_b16 v[124:125], v7 offset:38912
    ds_read_b64_tr_b16 v[126:127], v7 offset:39424
    s_cmp_eq_u32 s54, 7
    s_cbranch_scc1 L_q7
    s_barrier
    s_waitcnt lgkmcnt(6)
    v_mfma_f32_32x32x16_bf16 v[80:95], v[112:115], v[240:243], v[80:95]
    ds_read_b64_tr_b16 v[128:129], v6 offset:0
    ds_read_b64_tr_b16 v[130:131], v6 offset:512
    s_waitcnt lgkmcnt(6)
    v_mfma_f32_32x32x16_bf16 v[80:95], v[116:119], v[244:247], v[80:95]
    ds_read_b64_tr_b16 v[132:133], v6 offset:2048
    ds_read_b64_tr_b16 v[134:135], v6 offset:2560
    s_waitcnt lgkmcnt(6)
    v_mfma_f32_32x32x16_bf16 v[80:95], v[120:123], v[248:251], v[80:95]
    ds_read_b64_tr_b16 v[136:137], v6 offset:4096
    ds_read_b64_tr_b16 v[138:139], v6 offset:4608
    s_waitcnt lgkmcnt(6)
    v_mfma_f32_32x32x16_bf16 v[80:95], v[124:127], v[252:255], v[80:95]
    ds_read_b64_tr_b16 v[140:141], v6 offset:6144
    ds_read_b64_tr_b16 v[142:143], v6 offset:6656
    s_barrier
    s_waitcnt lgkmcnt(6)
    v_mfma_f32_32x32x16_bf16 v[64:79], v[144:147], v[128:131], 0
    ds_read_b64_tr_b16 v[112:113], v6 offset:8192
    ds_read_b64_tr_b16 v[114:115], v6 offset:8704
    s_waitcnt lgkmcnt(6)
    v_mfma_f32_32x32x16_bf16 v[64:79], v[148:151], v[132:135], v[64:79]
    ds_read_b64_tr_b16 v[116:117], v6 offset:10240
    ds_read_b64_tr_b16 v[118:119], v6 offset:10752
    s_waitcnt lgkmcnt(6)
    v_mfma_f32_32x32x16_bf16 v[64:79], v[152:155], v[136:139], v[64:79]
    ds_read_b64_tr_b16 v[120:121], v6 offset:12288
    ds_read_b64_tr_b16 v[122:123], v6 offset:12800
    s_waitcnt lgkmcnt(6)
    v_mfma_f32_32x32x16_bf16 v[64:79], v[156:159], v[140:143], v[64:79]
    ds_read_b64_tr_b16 v[124:125], v6 offset:14336
    ds_read_b64_tr_b16 v[126:127], v6 offset:14848
    s_barrier
    s_waitcnt lgkmcnt(6)
    v_mfma_f32_32x32x16_bf16 v[64:79], v[160:163], v[112:115], v[64:79]
    ds_read_b64_tr_b16 v[128:129], v6 offset:16384
    ds_read_b64_tr_b16 v[130:131], v6 offset:16896
    v_mul_f32 v80, v22, v80
    v_mul_f32 v81, v22, v81
    v_cvt_pk_bf16_f32 v24, v80, v81
    s_waitcnt lgkmcnt(6)
    v_mfma_f32_32x32x16_bf16 v[64:79], v[164:167], v[116:119], v[64:79]
    ds_read_b64_tr_b16 v[132:133], v6 offset:18432
    ds_read_b64_tr_b16 v[134:135], v6 offset:18944
    v_mul_f32 v82, v22, v82
    v_mul_f32 v83, v22, v83
    v_cvt_pk_bf16_f32 v25, v82, v83
    s_waitcnt lgkmcnt(6)
    v_mfma_f32_32x32x16_bf16 v[64:79], v[168:171], v[120:123], v[64:79]
    ds_read_b64_tr_b16 v[136:137], v6 offset:20480
    ds_read_b64_tr_b16 v[138:139], v6 offset:20992
    v_mul_f32 v84, s11, v84
    v_mul_f32 v85, s11, v85
    v_cvt_pk_bf16_f32 v26, v84, v85
    s_waitcnt lgkmcnt(6)
    v_mfma_f32_32x32x16_bf16 v[64:79], v[172:175], v[124:127], v[64:79]
    ds_read_b64_tr_b16 v[140:141], v6 offset:22528
    ds_read_b64_tr_b16 v[142:143], v6 offset:23040
    v_mul_f32 v86, s11, v86
    v_mul_f32 v87, s11, v87
    v_cvt_pk_bf16_f32 v27, v86, v87
    s_barrier
    s_waitcnt lgkmcnt(6)
    v_mfma_f32_32x32x16_bf16 v[64:79], v[176:179], v[128:131], v[64:79]
    ds_read_b64_tr_b16 v[112:113], v6 offset:24576
    ds_read_b64_tr_b16 v[114:115], v6 offset:25088
    v_mul_f32 v88, s11, v88
    v_mul_f32 v89, s11, v89
    v_cvt_pk_bf16_f32 v28, v88, v89
    s_waitcnt lgkmcnt(6)
    v_mfma_f32_32x32x16_bf16 v[64:79], v[180:183], v[132:135], v[64:79]
    ds_read_b64_tr_b16 v[116:117], v6 offset:26624
    ds_read_b64_tr_b16 v[118:119], v6 offset:27136
    v_mul_f32 v90, s11, v90
    v_mul_f32 v91, s11, v91
    v_cvt_pk_bf16_f32 v29, v90, v91
    s_waitcnt lgkmcnt(6)
    v_mfma_f32_32x32x16_bf16 v[64:79], v[184:187], v[136:139], v[64:79]
    ds_read_b64_tr_b16 v[120:121], v6 offset:28672
    ds_read_b64_tr_b16 v[122:123], v6 offset:29184
    v_mul_f32 v92, v23, v92
    v_mul_f32 v93, v23, v93
    v_cvt_pk_bf16_f32 v30, v92, v93
    s_waitcnt lgkmcnt(6)
    v_mfma_f32_32x32x16_bf16 v[64:79], v[188:191], v[140:143], v[64:79]
    ds_read_b64_tr_b16 v[124:125], v6 offset:30720
    ds_read_b64_tr_b16 v[126:127], v6 offset:31232
    v_mul_f32 v94, v23, v94
    v_mul_f32 v95, v23, v95
    v_cvt_pk_bf16_f32 v31, v94, v95
    s_barrier
    s_waitcnt lgkmcnt(6)
    v_mfma_f32_32x32x16_bf16 v[64:79], v[192:195], v[112:115], v[64:79]
    ds_read_b64_tr_b16 v[128:129], v6 offset:32768
    ds_read_b64_tr_b16 v[130:131], v6 offset:33280
    s_waitcnt lgkmcnt(6)
    v_mfma_f32_32x32x16_bf16 v[64:79], v[196:199], v[116:119], v[64:79]
    ds_read_b64_tr_b16 v[132:133], v6 offset:34816
    ds_read_b64_tr_b16 v[134:135], v6 offset:35328
    s_waitcnt lgkmcnt(6)
    v_mfma_f32_32x32x16_bf16 v[64:79], v[200:203], v[120:123], v[64:79]
    ds_read_b64_tr_b16 v[136:137], v6 offset:36864
    ds_read_b64_tr_b16 v[138:139], v6 offset:37376
    s_waitcnt lgkmcnt(6)
    v_mfma_f32_32x32x16_bf16 v[64:79], v[204:207], v[124:127], v[64:79]
    ds_read_b64_tr_b16 v[140:141], v6 offset:38912
    ds_read_b64_tr_b16 v[142:143], v6 offset:39424
    s_barrier
    s_waitcnt lgkmcnt(6)
    v_mfma_f32_32x32x16_bf16 v[64:79], v[208:211], v[128:131], v[64:79]
    ds_read_b64_tr_b16 v[112:113], v6 offset:40960
    ds_read_b64_tr_b16 v[114:115], v6 offset:41472
    s_waitcnt lgkmcnt(6)
    v_mfma_f32_32x32x16_bf16 v[64:79], v[212:215], v[132:135], v[64:79]
    ds_read_b64_tr_b16 v[116:117], v6 offset:43008
    ds_read_b64_tr_b16 v[118:119], v6 offset:43520
    s_waitcnt lgkmcnt(6)
    v_mfma_f32_32x32x16_bf16 v[64:79], v[216:219], v[136:139], v[64:79]
    ds_read_b64_tr_b16 v[120:121], v6 offset:45056
    ds_read_b64_tr_b16 v[122:123], v6 offset:45568
    s_waitcnt lgkmcnt(6)
    v_mfma_f32_32x32x16_bf16 v[64:79], v[220:223], v[140:143], v[64:79]
    ds_read_b64_tr_b16 v[124:125], v6 offset:47104
    ds_read_b64_tr_b16 v[126:127], v6 offset:47616
    s_barrier
    s_waitcnt lgkmcnt(6)
    v_mfma_f32_32x32x16_bf16 v[64:79], v[224:227], v[112:115], v[64:79]
    ds_read_b64_tr_b16 v[128:129], v6 offset:49152
    ds_read_b64_tr_b16 v[130:131], v6 offset:49664
    s_waitcnt lgkmcnt(6)
    v_mfma_f32_32x32x16_bf16 v[64:79], v[228:231], v[116:119], v[64:79]
    ds_read_b64_tr_b16 v[132:133], v6 offset:51200
    ds_read_b64_tr_b16 v[134:135], v6 offset:51712
    s_waitcnt lgkmcnt(6)
    v_mfma_f32_32x32x16_bf16 v[64:79], v[232:235], v[120:123], v[64:79]
    ds_read_b64_tr_b16 v[136:137], v6 offset:53248
    ds_read_b64_tr_b16 v[138:139], v6 offset:53760
    s_waitcnt lgkmcnt(6)
    v_mfma_f32_32x32x16_bf16 v[64:79], v[236:239], v[124:127], v[64:79]
    ds_read_b64_tr_b16 v[140:141], v6 offset:55296
    ds_read_b64_tr_b16 v[142:143], v6 offset:55808
    s_waitcnt lgkmcnt(6)
    v_mfma_f32_32x32x16_bf16 v[64:79], v[240:243], v[128:131], v[64:79]
    s_waitcnt lgkmcnt(4)
    v_mfma_f32_32x32x16_bf16 v[64:79], v[244:247], v[132:135], v[64:79]
    s_waitcnt lgkmcnt(2)
    v_mfma_f32_32x32x16_bf16 v[64:79], v[248:251], v[136:139], v[64:79]
    s_waitcnt lgkmcnt(0)
    v_mfma_f32_32x32x16_bf16 v[64:79], v[252:255], v[140:143], v[64:79]
    s_nop 11
    v_cvt_pk_bf16_f32 v96, v64, v65
    v_cvt_pk_bf16_f32 v97, v66, v67
    v_cvt_pk_bf16_f32 v98, v68, v69
    v_cvt_pk_bf16_f32 v99, v70, v71
    buffer_store_dwordx4 v[96:99], v10, s[44:47], s69 offen offset:0 sc1
    v_cvt_pk_bf16_f32 v100, v72, v73
    v_cvt_pk_bf16_f32 v101, v74, v75
    v_cvt_pk_bf16_f32 v102, v76, v77
    v_cvt_pk_bf16_f32 v103, v78, v79
    buffer_store_dwordx4 v[100:103], v10, s[44:47], s69 offen offset:1792 sc1
L_vdone:
    s_barrier
    s_barrier
    ds_read_b128 v[128:131], v14 offset:28672
    ds_read_b128 v[132:135], v14 offset:29696
    ds_read_b128 v[136:139], v14 offset:25088
    ds_read_b128 v[140:143], v14 offset:26112
    s_waitcnt lgkmcnt(2)
    v_mfma_f32_32x32x16_bf16 v[48:63], v[128:131], v[24:27], v[48:63]
    ds_read_b128 v[112:115], v14 offset:21504
    ds_read_b128 v[116:119], v14 offset:22528
    v_mfma_f32_32x32x16_bf16 v[48:63], v[132:135], v[28:31], v[48:63]
    s_mov_b32 s3, 0xc2200000
    s_nop 10
    v_max_f32 v40, v48, v49
    v_max_f32 v41, v50, v51
    v_max3_f32 v40, v40, v52, v53
    v_max3_f32 v41, v41, v54, v55
    v_max3_f32 v40, v40, v56, v57
    v_max3_f32 v41, v41, v58, v59
    v_max3_f32 v40, v40, v60, v61
    v_max3_f32 v41, v41, v62, v63
    v_max_f32 v42, v40, v41
    v_max_f32 v41, v40, v41
    s_nop 1
    v_permlane32_swap_b32 v42, v41
    v_max_f32 v40, v42, v41
    v_sub_f32 v40, s3, v40
    v_pk_mul_f32 v[96:97], v[40:41], 1.0 op_sel_hi:[0,0]
    v_pk_mul_f32 v[98:99], v[40:41], 1.0 op_sel_hi:[0,0]
    v_pk_mul_f32 v[100:101], v[40:41], 1.0 op_sel_hi:[0,0]
    v_pk_mul_f32 v[102:103], v[40:41], 1.0 op_sel_hi:[0,0]
    v_pk_mul_f32 v[104:105], v[40:41], 1.0 op_sel_hi:[0,0]
    v_pk_mul_f32 v[106:107], v[40:41], 1.0 op_sel_hi:[0,0]
    v_pk_mul_f32 v[108:109], v[40:41], 1.0 op_sel_hi:[0,0]
    v_pk_mul_f32 v[110:111], v[40:41], 1.0 op_sel_hi:[0,0]
    v_pk_add_f32 v[48:49], v[40:41], v[48:49] op_sel_hi:[0,1]
    v_pk_add_f32 v[50:51], v[40:41], v[50:51] op_sel_hi:[0,1]
    v_pk_add_f32 v[52:53], v[40:41], v[52:53] op_sel_hi:[0,1]
    v_pk_add_f32 v[54:55], v[40:41], v[54:55] op_sel_hi:[0,1]
    v_pk_add_f32 v[56:57], v[40:41], v[56:57] op_sel_hi:[0,1]
    v_pk_add_f32 v[58:59], v[40:41], v[58:59] op_sel_hi:[0,1]
    v_pk_add_f32 v[60:61], v[40:41], v[60:61] op_sel_hi:[0,1]
    v_pk_add_f32 v[62:63], v[40:41], v[62:63] op_sel_hi:[0,1]
    s_waitcnt vmcnt(0)
    s_barrier
    v_exp_f32 v48, v48
    s_waitcnt lgkmcnt(2)
    v_mfma_f32_32x32x16_bf16 v[240:255], v[136:139], v[24:27], v[96:111]
    ds_read_b128 v[120:123], v14 offset:17920
    ds_read_b128 v[124:127], v14 offset:18944
    v_exp_f32 v49, v49
    v_exp_f32 v50, v50
    v_exp_f32 v51, v51
    v_exp_f32 v52, v52
    v_exp_f32 v53, v53
    v_mfma_f32_32x32x16_bf16 v[240:255], v[140:143], v[28:31], v[240:255]
    v_exp_f32 v54, v54
    v_exp_f32 v55, v55
    v_cvt_pk_bf16_f32 v48, v48, v49
    v_cvt_pk_bf16_f32 v49, v50, v51
    v_cvt_pk_bf16_f32 v50, v52, v53
    v_cvt_pk_bf16_f32 v51, v54, v55
    v_exp_f32 v56, v56
    v_exp_f32 v57, v57
    v_exp_f32 v58, v58
    v_exp_f32 v59, v59
    v_exp_f32 v60, v60
    v_exp_f32 v61, v61
    v_exp_f32 v62, v62
    v_exp_f32 v63, v63
    v_cvt_pk_bf16_f32 v56, v56, v57
    v_cvt_pk_bf16_f32 v57, v58, v59
    v_cvt_pk_bf16_f32 v58, v60, v61
    v_cvt_pk_bf16_f32 v59, v62, v63
    v_exp_f32 v240, v240
    s_waitcnt lgkmcnt(2)
    v_mfma_f32_32x32x16_bf16 v[224:239], v[112:115], v[24:27], v[96:111]
    ds_read_b128 v[128:131], v14 offset:14336
    ds_read_b128 v[132:135], v14 offset:15360
    v_exp_f32 v241, v241
    v_exp_f32 v242, v242
    v_exp_f32 v243, v243
    v_exp_f32 v244, v244
    v_exp_f32 v245, v245
    v_mfma_f32_32x32x16_bf16 v[224:239], v[116:119], v[28:31], v[224:239]
    v_exp_f32 v246, v246
    v_exp_f32 v247, v247
    v_cvt_pk_bf16_f32 v240, v240, v241
    v_cvt_pk_bf16_f32 v241, v242, v243
    v_cvt_pk_bf16_f32 v242, v244, v245
    v_cvt_pk_bf16_f32 v243, v246, v247
    v_exp_f32 v248, v248
    v_exp_f32 v249, v249
    v_exp_f32 v250, v250
    v_exp_f32 v251, v251
    v_exp_f32 v252, v252
    v_exp_f32 v253, v253
    v_exp_f32 v254, v254
    v_exp_f32 v255, v255
    v_cvt_pk_bf16_f32 v248, v248, v249
    v_cvt_pk_bf16_f32 v249, v250, v251
    v_cvt_pk_bf16_f32 v250, v252, v253
    v_cvt_pk_bf16_f32 v251, v254, v255
    s_barrier
    v_exp_f32 v224, v224
    s_waitcnt lgkmcnt(2)
    v_mfma_f32_32x32x16_bf16 v[208:223], v[120:123], v[24:27], v[96:111]
    ds_read_b128 v[136:139], v14 offset:10752
    ds_read_b128 v[140:143], v14 offset:11776
    v_exp_f32 v225, v225
    v_exp_f32 v226, v226
    v_exp_f32 v227, v227
    v_exp_f32 v228, v228
    v_exp_f32 v229, v229
    v_mfma_f32_32x32x16_bf16 v[208:223], v[124:127], v[28:31], v[208:223]
    v_exp_f32 v230, v230
    v_exp_f32 v231, v231
    v_cvt_pk_bf16_f32 v224, v224, v225
    v_cvt_pk_bf16_f32 v225, v226, v227
    v_cvt_pk_bf16_f32 v226, v228, v229
    v_cvt_pk_bf16_f32 v227, v230, v231
    v_exp_f32 v232, v232
    v_exp_f32 v233, v233
    v_exp_f32 v234, v234
    v_exp_f32 v235, v235
    v_exp_f32 v236, v236
    v_exp_f32 v237, v237
    v_exp_f32 v238, v238
    v_exp_f32 v239, v239
    v_cvt_pk_bf16_f32 v232, v232, v233
    v_cvt_pk_bf16_f32 v233, v234, v235
    v_cvt_pk_bf16_f32 v234, v236, v237
    v_cvt_pk_bf16_f32 v235, v238, v239
    v_exp_f32 v208, v208
    s_waitcnt lgkmcnt(2)
    v_mfma_f32_32x32x16_bf16 v[192:207], v[128:131], v[24:27], v[96:111]
    ds_read_b128 v[112:115], v14 offset:7168
    ds_read_b128 v[116:119], v14 offset:8192
    v_exp_f32 v209, v209
    v_exp_f32 v210, v210
    v_exp_f32 v211, v211
    v_exp_f32 v212, v212
    v_exp_f32 v213, v213
    v_mfma_f32_32x32x16_bf16 v[192:207], v[132:135], v[28:31], v[192:207]
    v_exp_f32 v214, v214
    v_exp_f32 v215, v215
    v_cvt_pk_bf16_f32 v208, v208, v209
    v_cvt_pk_bf16_f32 v209, v210, v211
    v_cvt_pk_bf16_f32 v210, v212, v213
    v_cvt_pk_bf16_f32 v211, v214, v215
    v_exp_f32 v216, v216
    v_exp_f32 v217, v217
    v_exp_f32 v218, v218
    v_exp_f32 v219, v219
    v_exp_f32 v220, v220
    v_exp_f32 v221, v221
    v_exp_f32 v222, v222
    v_exp_f32 v223, v223
    v_cvt_pk_bf16_f32 v216, v216, v217
    v_cvt_pk_bf16_f32 v217, v218, v219
    v_cvt_pk_bf16_f32 v218, v220, v221
    v_cvt_pk_bf16_f32 v219, v222, v223
    v_exp_f32 v192, v192
    s_waitcnt lgkmcnt(2)
    v_mfma_f32_32x32x16_bf16 v[176:191], v[136:139], v[24:27], v[96:111]
    ds_read_b128 v[120:123], v14 offset:3584
    ds_read_b128 v[124:127], v14 offset:4608
    v_exp_f32 v193, v193
    v_exp_f32 v194, v194
    v_exp_f32 v195, v195
    v_exp_f32 v196, v196
    v_exp_f32 v197, v197
    v_mfma_f32_32x32x16_bf16 v[176:191], v[140:143], v[28:31], v[176:191]
    v_exp_f32 v198, v198
    v_exp_f32 v199, v199
    v_cvt_pk_bf16_f32 v192, v192, v193
    v_cvt_pk_bf16_f32 v193, v194, v195
    v_cvt_pk_bf16_f32 v194, v196, v197
    v_cvt_pk_bf16_f32 v195, v198, v199
    v_exp_f32 v200, v200
    v_exp_f32 v201, v201
    v_exp_f32 v202, v202
    v_exp_f32 v203, v203
    v_exp_f32 v204, v204
    v_exp_f32 v205, v205
    v_exp_f32 v206, v206
    v_exp_f32 v207, v207
    v_cvt_pk_bf16_f32 v200, v200, v201
    v_cvt_pk_bf16_f32 v201, v202, v203
    v_cvt_pk_bf16_f32 v202, v204, v205
    v_cvt_pk_bf16_f32 v203, v206, v207
    v_exp_f32 v176, v176
    s_waitcnt lgkmcnt(2)
    v_mfma_f32_32x32x16_bf16 v[160:175], v[112:115], v[24:27], v[96:111]
    ds_read_b128 v[128:131], v14 offset:0
    ds_read_b128 v[132:135], v14 offset:1024
    v_exp_f32 v177, v177
    v_exp_f32 v178, v178
    v_exp_f32 v179, v179
    v_exp_f32 v180, v180
    v_exp_f32 v181, v181
    v_mfma_f32_32x32x16_bf16 v[160:175], v[116:119], v[28:31], v[160:175]
    v_exp_f32 v182, v182
    v_exp_f32 v183, v183
    v_cvt_pk_bf16_f32 v176, v176, v177
    v_cvt_pk_bf16_f32 v177, v178, v179
    v_cvt_pk_bf16_f32 v178, v180, v181
    v_cvt_pk_bf16_f32 v179, v182, v183
    v_exp_f32 v184, v184
    v_exp_f32 v185, v185
    v_exp_f32 v186, v186
    v_exp_f32 v187, v187
    v_exp_f32 v188, v188
    v_exp_f32 v189, v189
    v_exp_f32 v190, v190
    v_exp_f32 v191, v191
    v_cvt_pk_bf16_f32 v184, v184, v185
    v_cvt_pk_bf16_f32 v185, v186, v187
    v_cvt_pk_bf16_f32 v186, v188, v189
    v_cvt_pk_bf16_f32 v187, v190, v191
    v_exp_f32 v160, v160
    s_waitcnt lgkmcnt(2)
    v_mfma_f32_32x32x16_bf16 v[144:159], v[120:123], v[24:27], v[96:111]
    v_exp_f32 v161, v161
    v_exp_f32 v162, v162
    v_exp_f32 v163, v163
    v_exp_f32 v164, v164
    v_exp_f32 v165, v165
    v_mfma_f32_32x32x16_bf16 v[144:159], v[124:127], v[28:31], v[144:159]
    v_exp_f32 v166, v166
    v_exp_f32 v167, v167
    v_cvt_pk_bf16_f32 v160, v160, v161
    v_cvt_pk_bf16_f32 v161, v162, v163
    v_cvt_pk_bf16_f32 v162, v164, v165
    v_cvt_pk_bf16_f32 v163, v166, v167
    v_exp_f32 v168, v168
    v_exp_f32 v169, v169
    v_exp_f32 v170, v170
    v_exp_f32 v171, v171
    v_exp_f32 v172, v172
    v_exp_f32 v173, v173
    v_exp_f32 v174, v174
    v_exp_f32 v175, v175
    v_cvt_pk_bf16_f32 v168, v168, v169
    v_cvt_pk_bf16_f32 v169, v170, v171
    v_cvt_pk_bf16_f32 v170, v172, v173
    v_cvt_pk_bf16_f32 v171, v174, v175
    v_exp_f32 v144, v144
    s_waitcnt lgkmcnt(0)
    v_mfma_f32_32x32x16_bf16 v[64:79], v[128:131], v[24:27], v[96:111]
    v_exp_f32 v145, v145
    v_exp_f32 v146, v146
    v_exp_f32 v147, v147
    v_exp_f32 v148, v148
    v_exp_f32 v149, v149
    v_mfma_f32_32x32x16_bf16 v[64:79], v[132:135], v[28:31], v[64:79]
    v_exp_f32 v150, v150
    v_exp_f32 v151, v151
    v_cvt_pk_bf16_f32 v144, v144, v145
    v_cvt_pk_bf16_f32 v145, v146, v147
    v_cvt_pk_bf16_f32 v146, v148, v149
    v_cvt_pk_bf16_f32 v147, v150, v151
    v_exp_f32 v152, v152
    v_exp_f32 v153, v153
    v_exp_f32 v154, v154
    v_exp_f32 v155, v155
    v_exp_f32 v156, v156
    v_exp_f32 v157, v157
    v_exp_f32 v158, v158
    v_exp_f32 v159, v159
    v_cvt_pk_bf16_f32 v152, v152, v153
    v_cvt_pk_bf16_f32 v153, v154, v155
    v_cvt_pk_bf16_f32 v154, v156, v157
    v_cvt_pk_bf16_f32 v155, v158, v159
    v_exp_f32 v64, v64
    v_exp_f32 v65, v65
    v_exp_f32 v66, v66
    v_exp_f32 v67, v67
    v_exp_f32 v68, v68
    v_exp_f32 v69, v69
    v_exp_f32 v70, v70
    v_exp_f32 v71, v71
    v_cvt_pk_bf16_f32 v64, v64, v65
    v_cvt_pk_bf16_f32 v65, v66, v67
    v_cvt_pk_bf16_f32 v66, v68, v69
    v_cvt_pk_bf16_f32 v67, v70, v71
    v_and_b32 v64, v64, v32
    v_and_b32 v65, v65, v33
    v_and_b32 v66, v66, v34
    v_and_b32 v67, v67, v35
    v_exp_f32 v72, v72
    v_exp_f32 v73, v73
    v_exp_f32 v74, v74
    v_exp_f32 v75, v75
    v_exp_f32 v76, v76
    v_exp_f32 v77, v77
    v_exp_f32 v78, v78
    v_exp_f32 v79, v79
    v_cvt_pk_bf16_f32 v72, v72, v73
    v_cvt_pk_bf16_f32 v73, v74, v75
    v_cvt_pk_bf16_f32 v74, v76, v77
    v_cvt_pk_bf16_f32 v75, v78, v79
    v_and_b32 v72, v72, v36
    v_and_b32 v73, v73, v37
    v_and_b32 v74, v74, v38
    v_and_b32 v75, v75, v39
    s_branch L_ja_g1p2
    .p2alignl 12, 0xbf810000
L_pad_g1p2:
    s_branch L_rolesdone
L_ja_g1p2:
    s_barrier
    ds_read_b32 v44, v19 offset:12
    ds_read_b128 v[52:55], v15 offset:32768
    ds_read_b128 v[60:63], v15 offset:34816
    ds_read_b128 v[244:247], v15 offset:28672
    ds_read_b128 v[252:255], v15 offset:30720
    ds_read_b128 v[228:231], v15 offset:24576
    ds_read_b128 v[236:239], v15 offset:26624
    s_waitcnt lgkmcnt(4)
    v_mfma_f32_32x32x16_bf16 v[80:95], v[52:55], v[48:51], 0
    v_mfma_f32_32x32x16_bf16 v[80:95], v[60:63], v[56:59], v[80:95]
    s_waitcnt lgkmcnt(2)
    v_mfma_f32_32x32x16_bf16 v[80:95], v[244:247], v[240:243], v[80:95]
    v_mfma_f32_32x32x16_bf16 v[80:95], v[252:255], v[248:251], v[80:95]
    s_barrier
    v_readfirstlane_b32 s70, v44
    s_waitcnt lgkmcnt(0)
    v_mfma_f32_32x32x16_bf16 v[80:95], v[228:231], v[224:227], v[80:95]
    ds_read_b128 v[212:215], v15 offset:20480
    ds_read_b128 v[220:223], v15 offset:22528
    ds_read_b128 v[196:199], v15 offset:16384
    ds_read_b128 v[204:207], v15 offset:18432
    v_mfma_f32_32x32x16_bf16 v[80:95], v[236:239], v[232:235], v[80:95]
    s_waitcnt lgkmcnt(2)
    v_mfma_f32_32x32x16_bf16 v[80:95], v[212:215], v[208:211], v[80:95]
    v_mfma_f32_32x32x16_bf16 v[80:95], v[220:223], v[216:219], v[80:95]
    s_barrier
    s_waitcnt lgkmcnt(0)
    v_mfma_f32_32x32x16_bf16 v[80:95], v[196:199], v[192:195], v[80:95]
    ds_read_b128 v[180:183], v15 offset:12288
    ds_read_b128 v[188:191], v15 offset:14336
    ds_read_b128 v[164:167], v15 offset:8192
    ds_read_b128 v[172:175], v15 offset:10240
    v_mfma_f32_32x32x16_bf16 v[80:95], v[204:207], v[200:203], v[80:95]
    s_waitcnt lgkmcnt(2)
    v_mfma_f32_32x32x16_bf16 v[80:95], v[180:183], v[176:179], v[80:95]
    v_mfma_f32_32x32x16_bf16 v[80:95], v[188:191], v[184:187], v[80:95]
    s_barrier
    s_waitcnt lgkmcnt(0)
    v_mfma_f32_32x32x16_bf16 v[80:95], v[164:167], v[160:163], v[80:95]
    ds_read_b128 v[148:151], v15 offset:4096
    ds_read_b128 v[156:159], v15 offset:6144
    ds_read_b128 v[68:71], v15 offset:0
    ds_read_b128 v[76:79], v15 offset:2048
    v_mfma_f32_32x32x16_bf16 v[80:95], v[172:175], v[168:171], v[80:95]
    s_waitcnt lgkmcnt(2)
    v_mfma_f32_32x32x16_bf16 v[80:95], v[148:151], v[144:147], v[80:95]
    v_mfma_f32_32x32x16_bf16 v[80:95], v[156:159], v[152:155], v[80:95]
    s_waitcnt lgkmcnt(0)
    v_mfma_f32_32x32x16_bf16 v[80:95], v[68:71], v[64:67], v[80:95]
    v_mfma_f32_32x32x16_bf16 v[80:95], v[76:79], v[72:75], v[80:95]
L_onorm:
    s_cmp_eq_u32 s70, 0
    s_nop 10
    v_mov_b32 v40, v92
    v_mov_b32 v41, v92
    s_nop 1
    v_permlane32_swap_b32 v40, v41
    v_rcp_f32 v41, v41
    s_cbranch_scc1 L_oslow
    v_pk_mul_f32 v[96:97], v[40:41], v[80:81] op_sel:[1,0]
    v_pk_mul_f32 v[98:99], v[40:41], v[82:83] op_sel:[1,0]
    v_cvt_pk_bf16_f32 v128, v96, v97
    v_cvt_pk_bf16_f32 v129, v98, v99
    buffer_store_dwordx2 v[128:129], v16, s[44:47], s73 offen offset:0 nt
    v_pk_mul_f32 v[100:101], v[40:41], v[84:85] op_sel:[1,0]
    v_pk_mul_f32 v[102:103], v[40:41], v[86:87] op_sel:[1,0]
    v_cvt_pk_bf16_f32 v130, v100, v101
    v_cvt_pk_bf16_f32 v131, v102, v103
    buffer_store_dwordx2 v[130:131], v16, s[44:47], s73 offen offset:512 nt
    v_pk_mul_f32 v[104:105], v[40:41], v[88:89] op_sel:[1,0]
    v_pk_mul_f32 v[106:107], v[40:41], v[90:91] op_sel:[1,0]
    v_cvt_pk_bf16_f32 v132, v104, v105
    v_cvt_pk_bf16_f32 v133, v106, v107
    buffer_store_dwordx2 v[132:133], v16, s[44:47], s73 offen offset:1024 nt
    v_pk_mul_f32 v[108:109], v[40:41], v[92:93] op_sel:[1,0]
    v_pk_mul_f32 v[110:111], v[40:41], v[94:95] op_sel:[1,0]
    v_cvt_pk_bf16_f32 v134, v108, v109
    v_cvt_pk_bf16_f32 v135, v110, v111
    s_mov_b32 exec_hi, 0
    buffer_store_dwordx2 v[134:135], v16, s[44:47], s73 offen offset:1536 nt
    s_mov_b64 exec, -1
L_ostored:
    v_mul_f32 v42, 0x47800000, v92
    v_mul_f32 v40, 0, v80
    v_mul_f32 v41, 0, v81
    v_fmac_f32 v40, 0, v42
    v_fmac_f32 v40, 0, v82
    v_fmac_f32 v41, 0, v83
    v_fmac_f32 v40, 0, v84
    v_fmac_f32 v41, 0, v85
    v_fmac_f32 v40, 0, v86
    v_fmac_f32 v41, 0, v87
    v_fmac_f32 v40, 0, v88
    v_fmac_f32 v41, 0, v89
    v_fmac_f32 v40, 0, v90
    v_fmac_f32 v41, 0, v91
    v_fmac_f32 v40, 0, v92
    v_fmac_f32 v41, 0, v93
    v_fmac_f32 v40, 0, v94
    v_fmac_f32 v41, 0, v95
    v_cmp_u_f32 vcc, v40, v41
    s_nop 0
    s_cbranch_vccnz L_fallback
L_ochecked:
    s_cmp_eq_u32 s54, 7
    s_cbranch_scc1 L_nobt
    s_barrier
L_nobt:
    s_mov_b64 exec, 1
    s_cmp_eq_u32 s70, 0
    s_waitcnt vmcnt(0)
    s_cbranch_scc1 L_ofslow
    buffer_store_dword v18, v11, s[44:47], s72 offen
L_oflagged:
    s_mov_b64 exec, -1
    s_cmp_eq_u32 s54, 7
    s_cbranch_scc1 L_g1end
    s_add_u32 m0, s76, 0
    s_mov_b32 s79, 0
poll_21:
    buffer_load_dword v44, v17, s[44:47], s74 offen offset:0 sc1
    s_add_u32 s79, s79, 1
    s_cmp_gt_u32 s79, 16384
    s_cbranch_scc1 poll_21_d
    s_waitcnt vmcnt(0)
    v_cmp_ne_u32 vcc, s6, v44
    s_nop 0
    s_cbranch_vccnz poll_21
poll_21_d:
L_oall:
    buffer_load_dwordx4 v13, s[44:47], s75 offen offset:0 sc1 lds
    buffer_load_dwordx4 v13, s[44:47], s75 offen offset:1024 sc1 lds
    s_add_u32 m0, s76, 8192
    s_add_u32 s75, s75, 4096
    buffer_load_dwordx4 v13, s[44:47], s75 offen offset:0 sc1 lds
    buffer_load_dwordx4 v13, s[44:47], s75 offen offset:1024 sc1 lds
    s_add_u32 m0, s76, 16384
    s_add_u32 s75, s75, 4096
    buffer_load_dwordx4 v13, s[44:47], s75 offen offset:0 sc1 lds
    buffer_load_dwordx4 v13, s[44:47], s75 offen offset:1024 sc1 lds
    s_add_u32 m0, s76, 24576
    s_add_u32 s75, s75, 4096
    buffer_load_dwordx4 v13, s[44:47], s75 offen offset:0 sc1 lds
    buffer_load_dwordx4 v13, s[44:47], s75 offen offset:1024 sc1 lds
    s_add_u32 m0, s76, 32768
    s_add_u32 s75, s75, 4096
    buffer_load_dwordx4 v13, s[44:47], s75 offen offset:0 sc1 lds
    buffer_load_dwordx4 v13, s[44:47], s75 offen offset:1024 sc1 lds
    s_waitcnt vmcnt(8)
    s_barrier
    s_add_u32 m0, s76, 106496
    s_add_u32 s75, s75, 4096
    buffer_load_dwordx4 v13, s[44:47], s75 offen offset:0 sc1 lds
    buffer_load_dwordx4 v13, s[44:47], s75 offen offset:1024 sc1 lds
    s_add_u32 m0, s76, 114688
    s_add_u32 s75, s75, 4096
    buffer_load_dwordx4 v13, s[44:47], s75 offen offset:0 sc1 lds
    buffer_load_dwordx4 v13, s[44:47], s75 offen offset:1024 sc1 lds
    s_waitcnt vmcnt(10)
    s_barrier
    s_waitcnt vmcnt(8)
    s_barrier
    s_waitcnt vmcnt(6)
    s_barrier
    s_waitcnt vmcnt(4)
    s_barrier
    s_waitcnt vmcnt(2)
    s_barrier
    s_waitcnt vmcnt(0)
    s_barrier
L_g1end:
L_end:
    s_endpgm
L_codeend:
L_fallback:
    s_cmp_lg_u32 s71, 0
    s_cbranch_scc1 L_ochecked
    s_mov_b32 s71, 1
    s_waitcnt vmcnt(0)
    v_cvt_f32_i32 v42, v21
    v_mul_f32 v42, 0xf1800000, v42
    v_add_f32 v64, 0xf1800000, v42
    v_add_f32 v65, 0x0, v42
    v_add_f32 v66, 0x71800000, v42
    v_add_f32 v67, 0x72000000, v42
    v_add_f32 v68, 0x72e00000, v42
    v_add_f32 v69, 0x73000000, v42
    v_add_f32 v70, 0x73100000, v42
    v_add_f32 v71, 0x73200000, v42
    v_add_f32 v72, 0x73700000, v42
    v_add_f32 v73, 0x73800000, v42
    v_add_f32 v74, 0x73880000, v42
    v_add_f32 v75, 0x73900000, v42
    v_add_f32 v76, 0x73b80000, v42
    v_add_f32 v77, 0x73c00000, v42
    v_add_f32 v78, 0x73c80000, v42
    v_add_f32 v79, 0x73d00000, v42
    v_min_f32 v64, 0, v64
    v_min_f32 v65, 0, v65
    v_min_f32 v66, 0, v66
    v_min_f32 v67, 0, v67
    v_min_f32 v68, 0, v68
    v_min_f32 v69, 0, v69
    v_min_f32 v70, 0, v70
    v_min_f32 v71, 0, v71
    v_min_f32 v72, 0, v72
    v_min_f32 v73, 0, v73
    v_min_f32 v74, 0, v74
    v_min_f32 v75, 0, v75
    v_min_f32 v76, 0, v76
    v_min_f32 v77, 0, v77
    v_min_f32 v78, 0, v78
    v_min_f32 v79, 0, v79
    v_cvt_f32_i32 v42, v21
    v_mul_f32 v42, 0x71800000, v42
    v_add_f32 v48, 0x0, v42
    v_add_f32 v49, 0xf1800000, v42
    v_add_f32 v50, 0xf2000000, v42
    v_add_f32 v51, 0xf2400000, v42
    v_add_f32 v52, 0xf3000000, v42
    v_add_f32 v53, 0xf3100000, v42
    v_add_f32 v54, 0xf3200000, v42
    v_add_f32 v55, 0xf3300000, v42
    v_add_f32 v56, 0xf3800000, v42
    v_add_f32 v57, 0xf3880000, v42
    v_add_f32 v58, 0xf3900000, v42
    v_add_f32 v59, 0xf3980000, v42
    v_add_f32 v60, 0xf3c00000, v42
    v_add_f32 v61, 0xf3c80000, v42
    v_add_f32 v62, 0xf3d00000, v42
    v_add_f32 v63, 0xf3d80000, v42
    v_min_f32 v48, 0, v48
    v_min_f32 v49, 0, v49
    v_min_f32 v50, 0, v50
    v_min_f32 v51, 0, v51
    v_min_f32 v52, 0, v52
    v_min_f32 v53, 0, v53
    v_min_f32 v54, 0, v54
    v_min_f32 v55, 0, v55
    v_min_f32 v56, 0, v56
    v_min_f32 v57, 0, v57
    v_min_f32 v58, 0, v58
    v_min_f32 v59, 0, v59
    v_min_f32 v60, 0, v60
    v_min_f32 v61, 0, v61
    v_min_f32 v62, 0, v62
    v_min_f32 v63, 0, v63
    v_mov_b32 v40, 0xf1800000
    ds_read_b128 v[112:115], v14 offset:0
    ds_read_b128 v[116:119], v14 offset:1024
    s_cmp_lt_u32 s67, 8
    s_cselect_b32 s3, 0xf1800000, 0
    v_min_f32 v64, s3, v64
    v_min_f32 v65, s3, v65
    v_min_f32 v66, s3, v66
    v_min_f32 v67, s3, v67
    v_min_f32 v68, s3, v68
    v_min_f32 v69, s3, v69
    v_min_f32 v70, s3, v70
    v_min_f32 v71, s3, v71
    v_min_f32 v72, s3, v72
    v_min_f32 v73, s3, v73
    v_min_f32 v74, s3, v74
    v_min_f32 v75, s3, v75
    v_min_f32 v76, s3, v76
    v_min_f32 v77, s3, v77
    v_min_f32 v78, s3, v78
    v_min_f32 v79, s3, v79
    s_waitcnt lgkmcnt(0)
    s_nop 0
    v_mfma_f32_32x32x16_bf16 v[64:79], v[112:115], v[24:27], v[64:79]
    v_mfma_f32_32x32x16_bf16 v[64:79], v[116:119], v[28:31], v[64:79]
    s_nop 11
    v_max3_f32 v40, v40, v64, v65
    v_max3_f32 v40, v40, v66, v67
    v_max3_f32 v40, v40, v68, v69
    v_max3_f32 v40, v40, v70, v71
    v_max3_f32 v40, v40, v72, v73
    v_max3_f32 v40, v40, v74, v75
    v_max3_f32 v40, v40, v76, v77
    v_max3_f32 v40, v40, v78, v79
    ds_read_b128 v[112:115], v14 offset:3584
    ds_read_b128 v[116:119], v14 offset:4608
    s_cmp_lt_u32 s67, 7
    s_cselect_b32 s3, 0xf1800000, 0
    v_mov_b32 v144, s3
    v_mov_b32 v145, s3
    v_mov_b32 v146, s3
    v_mov_b32 v147, s3
    v_mov_b32 v148, s3
    v_mov_b32 v149, s3
    v_mov_b32 v150, s3
    v_mov_b32 v151, s3
    v_mov_b32 v152, s3
    v_mov_b32 v153, s3
    v_mov_b32 v154, s3
    v_mov_b32 v155, s3
    v_mov_b32 v156, s3
    v_mov_b32 v157, s3
    v_mov_b32 v158, s3
    v_mov_b32 v159, s3
    s_waitcnt lgkmcnt(0)
    s_nop 0
    v_mfma_f32_32x32x16_bf16 v[144:159], v[112:115], v[24:27], v[144:159]
    v_mfma_f32_32x32x16_bf16 v[144:159], v[116:119], v[28:31], v[144:159]
    s_nop 11
    v_max3_f32 v40, v40, v144, v145
    v_max3_f32 v40, v40, v146, v147
    v_max3_f32 v40, v40, v148, v149
    v_max3_f32 v40, v40, v150, v151
    v_max3_f32 v40, v40, v152, v153
    v_max3_f32 v40, v40, v154, v155
    v_max3_f32 v40, v40, v156, v157
    v_max3_f32 v40, v40, v158, v159
    ds_read_b128 v[112:115], v14 offset:7168
    ds_read_b128 v[116:119], v14 offset:8192
    s_cmp_lt_u32 s67, 6
    s_cselect_b32 s3, 0xf1800000, 0
    v_mov_b32 v160, s3
    v_mov_b32 v161, s3
    v_mov_b32 v162, s3
    v_mov_b32 v163, s3
    v_mov_b32 v164, s3
    v_mov_b32 v165, s3
    v_mov_b32 v166, s3
    v_mov_b32 v167, s3
    v_mov_b32 v168, s3
    v_mov_b32 v169, s3
    v_mov_b32 v170, s3
    v_mov_b32 v171, s3
    v_mov_b32 v172, s3
    v_mov_b32 v173, s3
    v_mov_b32 v174, s3
    v_mov_b32 v175, s3
    s_waitcnt lgkmcnt(0)
    s_nop 0
    v_mfma_f32_32x32x16_bf16 v[160:175], v[112:115], v[24:27], v[160:175]
    v_mfma_f32_32x32x16_bf16 v[160:175], v[116:119], v[28:31], v[160:175]
    s_nop 11
    v_max3_f32 v40, v40, v160, v161
    v_max3_f32 v40, v40, v162, v163
    v_max3_f32 v40, v40, v164, v165
    v_max3_f32 v40, v40, v166, v167
    v_max3_f32 v40, v40, v168, v169
    v_max3_f32 v40, v40, v170, v171
    v_max3_f32 v40, v40, v172, v173
    v_max3_f32 v40, v40, v174, v175
    ds_read_b128 v[112:115], v14 offset:10752
    ds_read_b128 v[116:119], v14 offset:11776
    s_cmp_lt_u32 s67, 5
    s_cselect_b32 s3, 0xf1800000, 0
    v_mov_b32 v176, s3
    v_mov_b32 v177, s3
    v_mov_b32 v178, s3
    v_mov_b32 v179, s3
    v_mov_b32 v180, s3
    v_mov_b32 v181, s3
    v_mov_b32 v182, s3
    v_mov_b32 v183, s3
    v_mov_b32 v184, s3
    v_mov_b32 v185, s3
    v_mov_b32 v186, s3
    v_mov_b32 v187, s3
    v_mov_b32 v188, s3
    v_mov_b32 v189, s3
    v_mov_b32 v190, s3
    v_mov_b32 v191, s3
    s_waitcnt lgkmcnt(0)
    s_nop 0
    v_mfma_f32_32x32x16_bf16 v[176:191], v[112:115], v[24:27], v[176:191]
    v_mfma_f32_32x32x16_bf16 v[176:191], v[116:119], v[28:31], v[176:191]
    s_nop 11
    v_max3_f32 v40, v40, v176, v177
    v_max3_f32 v40, v40, v178, v179
    v_max3_f32 v40, v40, v180, v181
    v_max3_f32 v40, v40, v182, v183
    v_max3_f32 v40, v40, v184, v185
    v_max3_f32 v40, v40, v186, v187
    v_max3_f32 v40, v40, v188, v189
    v_max3_f32 v40, v40, v190, v191
    ds_read_b128 v[112:115], v14 offset:14336
    ds_read_b128 v[116:119], v14 offset:15360
    s_cmp_lt_u32 s67, 4
    s_cselect_b32 s3, 0xf1800000, 0
    v_mov_b32 v192, s3
    v_mov_b32 v193, s3
    v_mov_b32 v194, s3
    v_mov_b32 v195, s3
    v_mov_b32 v196, s3
    v_mov_b32 v197, s3
    v_mov_b32 v198, s3
    v_mov_b32 v199, s3
    v_mov_b32 v200, s3
    v_mov_b32 v201, s3
    v_mov_b32 v202, s3
    v_mov_b32 v203, s3
    v_mov_b32 v204, s3
    v_mov_b32 v205, s3
    v_mov_b32 v206, s3
    v_mov_b32 v207, s3
    s_waitcnt lgkmcnt(0)
    s_nop 0
    v_mfma_f32_32x32x16_bf16 v[192:207], v[112:115], v[24:27], v[192:207]
    v_mfma_f32_32x32x16_bf16 v[192:207], v[116:119], v[28:31], v[192:207]
    s_nop 11
    v_max3_f32 v40, v40, v192, v193
    v_max3_f32 v40, v40, v194, v195
    v_max3_f32 v40, v40, v196, v197
    v_max3_f32 v40, v40, v198, v199
    v_max3_f32 v40, v40, v200, v201
    v_max3_f32 v40, v40, v202, v203
    v_max3_f32 v40, v40, v204, v205
    v_max3_f32 v40, v40, v206, v207
    ds_read_b128 v[112:115], v14 offset:17920
    ds_read_b128 v[116:119], v14 offset:18944
    s_cmp_lt_u32 s67, 3
    s_cselect_b32 s3, 0xf1800000, 0
    v_mov_b32 v208, s3
    v_mov_b32 v209, s3
    v_mov_b32 v210, s3
    v_mov_b32 v211, s3
    v_mov_b32 v212, s3
    v_mov_b32 v213, s3
    v_mov_b32 v214, s3
    v_mov_b32 v215, s3
    v_mov_b32 v216, s3
    v_mov_b32 v217, s3
    v_mov_b32 v218, s3
    v_mov_b32 v219, s3
    v_mov_b32 v220, s3
    v_mov_b32 v221, s3
    v_mov_b32 v222, s3
    v_mov_b32 v223, s3
    s_waitcnt lgkmcnt(0)
    s_nop 0
    v_mfma_f32_32x32x16_bf16 v[208:223], v[112:115], v[24:27], v[208:223]
    v_mfma_f32_32x32x16_bf16 v[208:223], v[116:119], v[28:31], v[208:223]
    s_nop 11
    v_max3_f32 v40, v40, v208, v209
    v_max3_f32 v40, v40, v210, v211
    v_max3_f32 v40, v40, v212, v213
    v_max3_f32 v40, v40, v214, v215
    v_max3_f32 v40, v40, v216, v217
    v_max3_f32 v40, v40, v218, v219
    v_max3_f32 v40, v40, v220, v221
    v_max3_f32 v40, v40, v222, v223
    ds_read_b128 v[112:115], v14 offset:21504
    ds_read_b128 v[116:119], v14 offset:22528
    s_cmp_lt_u32 s67, 2
    s_cselect_b32 s3, 0xf1800000, 0
    v_mov_b32 v224, s3
    v_mov_b32 v225, s3
    v_mov_b32 v226, s3
    v_mov_b32 v227, s3
    v_mov_b32 v228, s3
    v_mov_b32 v229, s3
    v_mov_b32 v230, s3
    v_mov_b32 v231, s3
    v_mov_b32 v232, s3
    v_mov_b32 v233, s3
    v_mov_b32 v234, s3
    v_mov_b32 v235, s3
    v_mov_b32 v236, s3
    v_mov_b32 v237, s3
    v_mov_b32 v238, s3
    v_mov_b32 v239, s3
    s_waitcnt lgkmcnt(0)
    s_nop 0
    v_mfma_f32_32x32x16_bf16 v[224:239], v[112:115], v[24:27], v[224:239]
    v_mfma_f32_32x32x16_bf16 v[224:239], v[116:119], v[28:31], v[224:239]
    s_nop 11
    v_max3_f32 v40, v40, v224, v225
    v_max3_f32 v40, v40, v226, v227
    v_max3_f32 v40, v40, v228, v229
    v_max3_f32 v40, v40, v230, v231
    v_max3_f32 v40, v40, v232, v233
    v_max3_f32 v40, v40, v234, v235
    v_max3_f32 v40, v40, v236, v237
    v_max3_f32 v40, v40, v238, v239
    ds_read_b128 v[112:115], v14 offset:25088
    ds_read_b128 v[116:119], v14 offset:26112
    s_cmp_lt_u32 s67, 1
    s_cselect_b32 s3, 0xf1800000, 0
    v_mov_b32 v240, s3
    v_mov_b32 v241, s3
    v_mov_b32 v242, s3
    v_mov_b32 v243, s3
    v_mov_b32 v244, s3
    v_mov_b32 v245, s3
    v_mov_b32 v246, s3
    v_mov_b32 v247, s3
    v_mov_b32 v248, s3
    v_mov_b32 v249, s3
    v_mov_b32 v250, s3
    v_mov_b32 v251, s3
    v_mov_b32 v252, s3
    v_mov_b32 v253, s3
    v_mov_b32 v254, s3
    v_mov_b32 v255, s3
    s_waitcnt lgkmcnt(0)
    s_nop 0
    v_mfma_f32_32x32x16_bf16 v[240:255], v[112:115], v[24:27], v[240:255]
    v_mfma_f32_32x32x16_bf16 v[240:255], v[116:119], v[28:31], v[240:255]
    s_nop 11
    v_max3_f32 v40, v40, v240, v241
    v_max3_f32 v40, v40, v242, v243
    v_max3_f32 v40, v40, v244, v245
    v_max3_f32 v40, v40, v246, v247
    v_max3_f32 v40, v40, v248, v249
    v_max3_f32 v40, v40, v250, v251
    v_max3_f32 v40, v40, v252, v253
    v_max3_f32 v40, v40, v254, v255
    ds_read_b128 v[112:115], v14 offset:28672
    ds_read_b128 v[116:119], v14 offset:29696
    s_waitcnt lgkmcnt(0)
    v_mfma_f32_32x32x16_bf16 v[48:63], v[112:115], v[24:27], v[48:63]
    v_mfma_f32_32x32x16_bf16 v[48:63], v[116:119], v[28:31], v[48:63]
    s_nop 11
    v_max3_f32 v40, v40, v48, v49
    v_max3_f32 v40, v40, v50, v51
    v_max3_f32 v40, v40, v52, v53
    v_max3_f32 v40, v40, v54, v55
    v_max3_f32 v40, v40, v56, v57
    v_max3_f32 v40, v40, v58, v59
    v_max3_f32 v40, v40, v60, v61
    v_max3_f32 v40, v40, v62, v63
    v_mov_b32 v41, v40
    s_nop 1
    v_permlane32_swap_b32 v40, v41
    v_max_f32 v40, v40, v41
    ds_read_b128 v[128:131], v15 offset:0
    ds_read_b128 v[132:135], v15 offset:2048
    v_sub_f32 v64, v64, v40
    v_sub_f32 v65, v65, v40
    v_sub_f32 v66, v66, v40
    v_sub_f32 v67, v67, v40
    v_sub_f32 v68, v68, v40
    v_sub_f32 v69, v69, v40
    v_sub_f32 v70, v70, v40
    v_sub_f32 v71, v71, v40
    v_sub_f32 v72, v72, v40
    v_sub_f32 v73, v73, v40
    v_sub_f32 v74, v74, v40
    v_sub_f32 v75, v75, v40
    v_sub_f32 v76, v76, v40
    v_sub_f32 v77, v77, v40
    v_sub_f32 v78, v78, v40
    v_sub_f32 v79, v79, v40
    v_exp_f32 v64, v64
    v_exp_f32 v65, v65
    v_exp_f32 v66, v66
    v_exp_f32 v67, v67
    v_exp_f32 v68, v68
    v_exp_f32 v69, v69
    v_exp_f32 v70, v70
    v_exp_f32 v71, v71
    v_exp_f32 v72, v72
    v_exp_f32 v73, v73
    v_exp_f32 v74, v74
    v_exp_f32 v75, v75
    v_exp_f32 v76, v76
    v_exp_f32 v77, v77
    v_exp_f32 v78, v78
    v_exp_f32 v79, v79
    v_cvt_pk_bf16_f32 v64, v64, v65
    v_cvt_pk_bf16_f32 v65, v66, v67
    v_cvt_pk_bf16_f32 v66, v68, v69
    v_cvt_pk_bf16_f32 v67, v70, v71
    v_cvt_pk_bf16_f32 v68, v72, v73
    v_cvt_pk_bf16_f32 v69, v74, v75
    v_cvt_pk_bf16_f32 v70, v76, v77
    v_cvt_pk_bf16_f32 v71, v78, v79
    s_waitcnt lgkmcnt(0)
    v_mfma_f32_32x32x16_bf16 v[80:95], v[128:131], v[64:67], 0
    v_mfma_f32_32x32x16_bf16 v[80:95], v[132:135], v[68:71], v[80:95]
    ds_read_b128 v[128:131], v15 offset:4096
    ds_read_b128 v[132:135], v15 offset:6144
    v_sub_f32 v144, v144, v40
    v_sub_f32 v145, v145, v40
    v_sub_f32 v146, v146, v40
    v_sub_f32 v147, v147, v40
    v_sub_f32 v148, v148, v40
    v_sub_f32 v149, v149, v40
    v_sub_f32 v150, v150, v40
    v_sub_f32 v151, v151, v40
    v_sub_f32 v152, v152, v40
    v_sub_f32 v153, v153, v40
    v_sub_f32 v154, v154, v40
    v_sub_f32 v155, v155, v40
    v_sub_f32 v156, v156, v40
    v_sub_f32 v157, v157, v40
    v_sub_f32 v158, v158, v40
    v_sub_f32 v159, v159, v40
    v_exp_f32 v144, v144
    v_exp_f32 v145, v145
    v_exp_f32 v146, v146
    v_exp_f32 v147, v147
    v_exp_f32 v148, v148
    v_exp_f32 v149, v149
    v_exp_f32 v150, v150
    v_exp_f32 v151, v151
    v_exp_f32 v152, v152
    v_exp_f32 v153, v153
    v_exp_f32 v154, v154
    v_exp_f32 v155, v155
    v_exp_f32 v156, v156
    v_exp_f32 v157, v157
    v_exp_f32 v158, v158
    v_exp_f32 v159, v159
    v_cvt_pk_bf16_f32 v144, v144, v145
    v_cvt_pk_bf16_f32 v145, v146, v147
    v_cvt_pk_bf16_f32 v146, v148, v149
    v_cvt_pk_bf16_f32 v147, v150, v151
    v_cvt_pk_bf16_f32 v148, v152, v153
    v_cvt_pk_bf16_f32 v149, v154, v155
    v_cvt_pk_bf16_f32 v150, v156, v157
    v_cvt_pk_bf16_f32 v151, v158, v159
    s_waitcnt lgkmcnt(0)
    v_mfma_f32_32x32x16_bf16 v[80:95], v[128:131], v[144:147], v[80:95]
    v_mfma_f32_32x32x16_bf16 v[80:95], v[132:135], v[148:151], v[80:95]
    ds_read_b128 v[128:131], v15 offset:8192
    ds_read_b128 v[132:135], v15 offset:10240
    v_sub_f32 v160, v160, v40
    v_sub_f32 v161, v161, v40
    v_sub_f32 v162, v162, v40
    v_sub_f32 v163, v163, v40
    v_sub_f32 v164, v164, v40
    v_sub_f32 v165, v165, v40
    v_sub_f32 v166, v166, v40
    v_sub_f32 v167, v167, v40
    v_sub_f32 v168, v168, v40
    v_sub_f32 v169, v169, v40
    v_sub_f32 v170, v170, v40
    v_sub_f32 v171, v171, v40
    v_sub_f32 v172, v172, v40
    v_sub_f32 v173, v173, v40
    v_sub_f32 v174, v174, v40
    v_sub_f32 v175, v175, v40
    v_exp_f32 v160, v160
    v_exp_f32 v161, v161
    v_exp_f32 v162, v162
    v_exp_f32 v163, v163
    v_exp_f32 v164, v164
    v_exp_f32 v165, v165
    v_exp_f32 v166, v166
    v_exp_f32 v167, v167
    v_exp_f32 v168, v168
    v_exp_f32 v169, v169
    v_exp_f32 v170, v170
    v_exp_f32 v171, v171
    v_exp_f32 v172, v172
    v_exp_f32 v173, v173
    v_exp_f32 v174, v174
    v_exp_f32 v175, v175
    v_cvt_pk_bf16_f32 v160, v160, v161
    v_cvt_pk_bf16_f32 v161, v162, v163
    v_cvt_pk_bf16_f32 v162, v164, v165
    v_cvt_pk_bf16_f32 v163, v166, v167
    v_cvt_pk_bf16_f32 v164, v168, v169
    v_cvt_pk_bf16_f32 v165, v170, v171
    v_cvt_pk_bf16_f32 v166, v172, v173
    v_cvt_pk_bf16_f32 v167, v174, v175
    s_waitcnt lgkmcnt(0)
    v_mfma_f32_32x32x16_bf16 v[80:95], v[128:131], v[160:163], v[80:95]
    v_mfma_f32_32x32x16_bf16 v[80:95], v[132:135], v[164:167], v[80:95]
    ds_read_b128 v[128:131], v15 offset:12288
    ds_read_b128 v[132:135], v15 offset:14336
    v_sub_f32 v176, v176, v40
    v_sub_f32 v177, v177, v40
    v_sub_f32 v178, v178, v40
    v_sub_f32 v179, v179, v40
    v_sub_f32 v180, v180, v40
    v_sub_f32 v181, v181, v40
    v_sub_f32 v182, v182, v40
    v_sub_f32 v183, v183, v40
    v_sub_f32 v184, v184, v40
    v_sub_f32 v185, v185, v40
    v_sub_f32 v186, v186, v40
    v_sub_f32 v187, v187, v40
    v_sub_f32 v188, v188, v40
    v_sub_f32 v189, v189, v40
    v_sub_f32 v190, v190, v40
    v_sub_f32 v191, v191, v40
    v_exp_f32 v176, v176
    v_exp_f32 v177, v177
    v_exp_f32 v178, v178
    v_exp_f32 v179, v179
    v_exp_f32 v180, v180
    v_exp_f32 v181, v181
    v_exp_f32 v182, v182
    v_exp_f32 v183, v183
    v_exp_f32 v184, v184
    v_exp_f32 v185, v185
    v_exp_f32 v186, v186
    v_exp_f32 v187, v187
    v_exp_f32 v188, v188
    v_exp_f32 v189, v189
    v_exp_f32 v190, v190
    v_exp_f32 v191, v191
    v_cvt_pk_bf16_f32 v176, v176, v177
    v_cvt_pk_bf16_f32 v177, v178, v179
    v_cvt_pk_bf16_f32 v178, v180, v181
    v_cvt_pk_bf16_f32 v179, v182, v183
    v_cvt_pk_bf16_f32 v180, v184, v185
    v_cvt_pk_bf16_f32 v181, v186, v187
    v_cvt_pk_bf16_f32 v182, v188, v189
    v_cvt_pk_bf16_f32 v183, v190, v191
    s_waitcnt lgkmcnt(0)
    v_mfma_f32_32x32x16_bf16 v[80:95], v[128:131], v[176:179], v[80:95]
    v_mfma_f32_32x32x16_bf16 v[80:95], v[132:135], v[180:183], v[80:95]
    ds_read_b128 v[128:131], v15 offset:16384
    ds_read_b128 v[132:135], v15 offset:18432
    v_sub_f32 v192, v192, v40
    v_sub_f32 v193, v193, v40
    v_sub_f32 v194, v194, v40
    v_sub_f32 v195, v195, v40
    v_sub_f32 v196, v196, v40
    v_sub_f32 v197, v197, v40
    v_sub_f32 v198, v198, v40
    v_sub_f32 v199, v199, v40
    v_sub_f32 v200, v200, v40
    v_sub_f32 v201, v201, v40
    v_sub_f32 v202, v202, v40
    v_sub_f32 v203, v203, v40
    v_sub_f32 v204, v204, v40
    v_sub_f32 v205, v205, v40
    v_sub_f32 v206, v206, v40
    v_sub_f32 v207, v207, v40
    v_exp_f32 v192, v192
    v_exp_f32 v193, v193
    v_exp_f32 v194, v194
    v_exp_f32 v195, v195
    v_exp_f32 v196, v196
    v_exp_f32 v197, v197
    v_exp_f32 v198, v198
    v_exp_f32 v199, v199
    v_exp_f32 v200, v200
    v_exp_f32 v201, v201
    v_exp_f32 v202, v202
    v_exp_f32 v203, v203
    v_exp_f32 v204, v204
    v_exp_f32 v205, v205
    v_exp_f32 v206, v206
    v_exp_f32 v207, v207
    v_cvt_pk_bf16_f32 v192, v192, v193
    v_cvt_pk_bf16_f32 v193, v194, v195
    v_cvt_pk_bf16_f32 v194, v196, v197
    v_cvt_pk_bf16_f32 v195, v198, v199
    v_cvt_pk_bf16_f32 v196, v200, v201
    v_cvt_pk_bf16_f32 v197, v202, v203
    v_cvt_pk_bf16_f32 v198, v204, v205
    v_cvt_pk_bf16_f32 v199, v206, v207
    s_waitcnt lgkmcnt(0)
    v_mfma_f32_32x32x16_bf16 v[80:95], v[128:131], v[192:195], v[80:95]
    v_mfma_f32_32x32x16_bf16 v[80:95], v[132:135], v[196:199], v[80:95]
    ds_read_b128 v[128:131], v15 offset:20480
    ds_read_b128 v[132:135], v15 offset:22528
    v_sub_f32 v208, v208, v40
    v_sub_f32 v209, v209, v40
    v_sub_f32 v210, v210, v40
    v_sub_f32 v211, v211, v40
    v_sub_f32 v212, v212, v40
    v_sub_f32 v213, v213, v40
    v_sub_f32 v214, v214, v40
    v_sub_f32 v215, v215, v40
    v_sub_f32 v216, v216, v40
    v_sub_f32 v217, v217, v40
    v_sub_f32 v218, v218, v40
    v_sub_f32 v219, v219, v40
    v_sub_f32 v220, v220, v40
    v_sub_f32 v221, v221, v40
    v_sub_f32 v222, v222, v40
    v_sub_f32 v223, v223, v40
    v_exp_f32 v208, v208
    v_exp_f32 v209, v209
    v_exp_f32 v210, v210
    v_exp_f32 v211, v211
    v_exp_f32 v212, v212
    v_exp_f32 v213, v213
    v_exp_f32 v214, v214
    v_exp_f32 v215, v215
    v_exp_f32 v216, v216
    v_exp_f32 v217, v217
    v_exp_f32 v218, v218
    v_exp_f32 v219, v219
    v_exp_f32 v220, v220
    v_exp_f32 v221, v221
    v_exp_f32 v222, v222
    v_exp_f32 v223, v223
    v_cvt_pk_bf16_f32 v208, v208, v209
    v_cvt_pk_bf16_f32 v209, v210, v211
    v_cvt_pk_bf16_f32 v210, v212, v213
    v_cvt_pk_bf16_f32 v211, v214, v215
    v_cvt_pk_bf16_f32 v212, v216, v217
    v_cvt_pk_bf16_f32 v213, v218, v219
    v_cvt_pk_bf16_f32 v214, v220, v221
    v_cvt_pk_bf16_f32 v215, v222, v223
    s_waitcnt lgkmcnt(0)
    v_mfma_f32_32x32x16_bf16 v[80:95], v[128:131], v[208:211], v[80:95]
    v_mfma_f32_32x32x16_bf16 v[80:95], v[132:135], v[212:215], v[80:95]
    ds_read_b128 v[128:131], v15 offset:24576
    ds_read_b128 v[132:135], v15 offset:26624
    v_sub_f32 v224, v224, v40
    v_sub_f32 v225, v225, v40
    v_sub_f32 v226, v226, v40
    v_sub_f32 v227, v227, v40
    v_sub_f32 v228, v228, v40
    v_sub_f32 v229, v229, v40
    v_sub_f32 v230, v230, v40
    v_sub_f32 v231, v231, v40
    v_sub_f32 v232, v232, v40
    v_sub_f32 v233, v233, v40
    v_sub_f32 v234, v234, v40
    v_sub_f32 v235, v235, v40
    v_sub_f32 v236, v236, v40
    v_sub_f32 v237, v237, v40
    v_sub_f32 v238, v238, v40
    v_sub_f32 v239, v239, v40
    v_exp_f32 v224, v224
    v_exp_f32 v225, v225
    v_exp_f32 v226, v226
    v_exp_f32 v227, v227
    v_exp_f32 v228, v228
    v_exp_f32 v229, v229
    v_exp_f32 v230, v230
    v_exp_f32 v231, v231
    v_exp_f32 v232, v232
    v_exp_f32 v233, v233
    v_exp_f32 v234, v234
    v_exp_f32 v235, v235
    v_exp_f32 v236, v236
    v_exp_f32 v237, v237
    v_exp_f32 v238, v238
    v_exp_f32 v239, v239
    v_cvt_pk_bf16_f32 v224, v224, v225
    v_cvt_pk_bf16_f32 v225, v226, v227
    v_cvt_pk_bf16_f32 v226, v228, v229
    v_cvt_pk_bf16_f32 v227, v230, v231
    v_cvt_pk_bf16_f32 v228, v232, v233
    v_cvt_pk_bf16_f32 v229, v234, v235
    v_cvt_pk_bf16_f32 v230, v236, v237
    v_cvt_pk_bf16_f32 v231, v238, v239
    s_waitcnt lgkmcnt(0)
    v_mfma_f32_32x32x16_bf16 v[80:95], v[128:131], v[224:227], v[80:95]
    v_mfma_f32_32x32x16_bf16 v[80:95], v[132:135], v[228:231], v[80:95]
    ds_read_b128 v[128:131], v15 offset:28672
    ds_read_b128 v[132:135], v15 offset:30720
    v_sub_f32 v240, v240, v40
    v_sub_f32 v241, v241, v40
    v_sub_f32 v242, v242, v40
    v_sub_f32 v243, v243, v40
    v_sub_f32 v244, v244, v40
    v_sub_f32 v245, v245, v40
    v_sub_f32 v246, v246, v40
    v_sub_f32 v247, v247, v40
    v_sub_f32 v248, v248, v40
    v_sub_f32 v249, v249, v40
    v_sub_f32 v250, v250, v40
    v_sub_f32 v251, v251, v40
    v_sub_f32 v252, v252, v40
    v_sub_f32 v253, v253, v40
    v_sub_f32 v254, v254, v40
    v_sub_f32 v255, v255, v40
    v_exp_f32 v240, v240
    v_exp_f32 v241, v241
    v_exp_f32 v242, v242
    v_exp_f32 v243, v243
    v_exp_f32 v244, v244
    v_exp_f32 v245, v245
    v_exp_f32 v246, v246
    v_exp_f32 v247, v247
    v_exp_f32 v248, v248
    v_exp_f32 v249, v249
    v_exp_f32 v250, v250
    v_exp_f32 v251, v251
    v_exp_f32 v252, v252
    v_exp_f32 v253, v253
    v_exp_f32 v254, v254
    v_exp_f32 v255, v255
    v_cvt_pk_bf16_f32 v240, v240, v241
    v_cvt_pk_bf16_f32 v241, v242, v243
    v_cvt_pk_bf16_f32 v242, v244, v245
    v_cvt_pk_bf16_f32 v243, v246, v247
    v_cvt_pk_bf16_f32 v244, v248, v249
    v_cvt_pk_bf16_f32 v245, v250, v251
    v_cvt_pk_bf16_f32 v246, v252, v253
    v_cvt_pk_bf16_f32 v247, v254, v255
    s_waitcnt lgkmcnt(0)
    v_mfma_f32_32x32x16_bf16 v[80:95], v[128:131], v[240:243], v[80:95]
    v_mfma_f32_32x32x16_bf16 v[80:95], v[132:135], v[244:247], v[80:95]
    ds_read_b128 v[128:131], v15 offset:32768
    ds_read_b128 v[132:135], v15 offset:34816
    v_sub_f32 v48, v48, v40
    v_sub_f32 v49, v49, v40
    v_sub_f32 v50, v50, v40
    v_sub_f32 v51, v51, v40
    v_sub_f32 v52, v52, v40
    v_sub_f32 v53, v53, v40
    v_sub_f32 v54, v54, v40
    v_sub_f32 v55, v55, v40
    v_sub_f32 v56, v56, v40
    v_sub_f32 v57, v57, v40
    v_sub_f32 v58, v58, v40
    v_sub_f32 v59, v59, v40
    v_sub_f32 v60, v60, v40
    v_sub_f32 v61, v61, v40
    v_sub_f32 v62, v62, v40
    v_sub_f32 v63, v63, v40
    v_exp_f32 v48, v48
    v_exp_f32 v49, v49
    v_exp_f32 v50, v50
    v_exp_f32 v51, v51
    v_exp_f32 v52, v52
    v_exp_f32 v53, v53
    v_exp_f32 v54, v54
    v_exp_f32 v55, v55
    v_exp_f32 v56, v56
    v_exp_f32 v57, v57
    v_exp_f32 v58, v58
    v_exp_f32 v59, v59
    v_exp_f32 v60, v60
    v_exp_f32 v61, v61
    v_exp_f32 v62, v62
    v_exp_f32 v63, v63
    v_cvt_pk_bf16_f32 v48, v48, v49
    v_cvt_pk_bf16_f32 v49, v50, v51
    v_cvt_pk_bf16_f32 v50, v52, v53
    v_cvt_pk_bf16_f32 v51, v54, v55
    v_cvt_pk_bf16_f32 v52, v56, v57
    v_cvt_pk_bf16_f32 v53, v58, v59
    v_cvt_pk_bf16_f32 v54, v60, v61
    v_cvt_pk_bf16_f32 v55, v62, v63
    s_waitcnt lgkmcnt(0)
    v_mfma_f32_32x32x16_bf16 v[80:95], v[128:131], v[48:51], v[80:95]
    v_mfma_f32_32x32x16_bf16 v[80:95], v[132:135], v[52:55], v[80:95]
    s_nop 11
    s_branch L_onorm
    s_endpgm
.section .rodata,"a"
.p2align 6
.amdhsa_kernel concat_heads__spectral_fnet__sliding_block__prompt_kernel
  .amdhsa_next_free_vgpr 256
  .amdhsa_next_free_sgpr 102
  .amdhsa_accum_offset 256
  .amdhsa_group_segment_fixed_size 0
  .amdhsa_kernarg_size 88
  .amdhsa_user_sgpr_count 2
  .amdhsa_user_sgpr_kernarg_segment_ptr 1
  .amdhsa_system_sgpr_workgroup_id_x 1
.end_amdhsa_kernel
```
